```python
import torch

def _softmax(x, axis=-1):
    return torch.softmax(x, dim=axis)
def _gelu(x):
    return torch.nn.functional.gelu(x, approximate="tanh")
def _silu(x):
    return torch.nn.functional.silu(x)
def _sigmoid(x):
    return torch.sigmoid(x)
def _layernorm(x, axis=-1, eps=1e-5):
    m = x.mean(dim=axis, keepdim=True)
    v = x.var(dim=axis, keepdim=True, unbiased=False)
    return (x - m) / torch.sqrt(v + eps)
def _scatter_add(tgt, idx, src, axis=0):
    return tgt.clone().index_add_(axis, idx, src)
def _segment_sum(src, seg, n):
    out = torch.zeros((n,) + src.shape[1:], dtype=src.dtype)
    return out.index_add_(0, seg, src)
def _pad(x, pw):
    flat = tuple(v for pair in reversed(pw) for v in pair)
    return torch.nn.functional.pad(x, flat)

kernel_name = 'gated_mix__ssm_conv_h3__spectral_fnet__prompt'

def setup_inputs():

    _w = (lambda a: (lambda t: t.to(torch.bfloat16) if t.is_floating_point() else t)(torch.as_tensor(a)))
    def _A_setup():
        B, S, D = 1, 2048, 512
        ks = 4
        return {
            "q": _w((lambda *s: torch.randn(*s, dtype=torch.bfloat16) * 0.05)(B, S, D)),
            "k": _w((lambda *s: torch.randn(*s, dtype=torch.bfloat16) * 3.2)(B, S, D)),
            "v": _w((lambda *s: torch.randn(*s, dtype=torch.bfloat16) * 3.2)(B, S, D)),
            "shift_k": _w((lambda *s: torch.randn(*s, dtype=torch.bfloat16) * 3.2)(D, ks) * 0.5),
            "ssm_k": _w((lambda *s: torch.randn(*s, dtype=torch.bfloat16) * 3.2)(D, S) * (1.0 / S ** 0.5)),
            "ssm_D": _w((lambda *s: torch.randn(*s, dtype=torch.bfloat16) * 3.2)(D)),
        }
    _A_in = _A_setup()

    def _B_setup():
        B, S, D = 1, 2048, 512
        ns = torch.arange(S)[:, None] * torch.arange(S)[None, :]
        nd = torch.arange(D)[:, None] * torch.arange(D)[None, :]
        Ws_re = torch.cos(-2.0 * torch.pi * ns / S).to(float)
        Ws_im = torch.sin(-2.0 * torch.pi * ns / S).to(float)
        Wd_re = torch.cos(-2.0 * torch.pi * nd / D).to(float)
        Wd_im = torch.sin(-2.0 * torch.pi * nd / D).to(float)
        return {
            "x": _w((lambda *s: torch.randn(*s, dtype=torch.bfloat16) * 0.05)(B, S, D)),
            "dft_seq_re": _w(Ws_re),
            "dft_seq_im": _w(Ws_im),
            "dft_hid_re": _w(Wd_re),
            "dft_hid_im": _w(Wd_im),
        }
    _B_in = _B_setup()

    return {
        "A_q": _A_in["q"],
        "A_k": _A_in["k"],
        "A_v": _A_in["v"],
        "A_shift_k": _A_in["shift_k"],
        "A_ssm_k": _A_in["ssm_k"],
        "A_ssm_D": _A_in["ssm_D"],
        "B_x": _B_in["x"],
        "B_dft_seq_re": _B_in["dft_seq_re"],
        "B_dft_seq_im": _B_in["dft_seq_im"],
        "B_dft_hid_re": _B_in["dft_hid_re"],
        "B_dft_hid_im": _B_in["dft_hid_im"],
        "gate_w": _w((lambda *s: torch.randn(*s, dtype=torch.bfloat16) * 0.05)(512) * 16.0),
    }

def reference(A_q, A_k, A_v, A_shift_k, A_ssm_k, A_ssm_D, B_x, B_dft_seq_re, B_dft_seq_im, B_dft_hid_re, B_dft_hid_im, gate_w):
    def _A_ref(q, k, v, shift_k, ssm_k, ssm_D):
        B, S, D = q.shape
        ks = shift_k.shape[-1]
        k_pad = _pad(k, ((0, 0), (ks - 1, 0), (0, 0)))
        k_shift = torch.zeros_like(k)
        for t in range(ks):
            k_shift = k_shift + k_pad[:, t:t + S, :] * shift_k[:, ks - 1 - t][None, None, :]
        kv = k_shift * v
        L = 2 * S
        kv_pad = _pad(kv, ((0, 0), (0, S), (0, 0)))
        kf_pad = _pad(ssm_k, ((0, 0), (0, S)))
        kv_f = (lambda x, axes=(-2,-1): torch.fft.rfft2(x.float(), dim=axes))(kv_pad[:, None, :, :], axes=(1, 2))
        kf_f = (lambda x, axes=(-2,-1): torch.fft.rfft2(x.float(), dim=axes))(kf_pad[:, None, :], axes=(1, 2))
        kf_f = (lambda x, *d: x.permute(*d))(kf_f, 1, 2, 0)
        y_f = kv_f * kf_f[None, :, :, :]
        y = (lambda x, s, axes=(-2,-1): torch.fft.irfft2(x, s=s, dim=axes).to(torch.bfloat16))(y_f, (1, L), axes=(1, 2))[:, 0, :S, :]
        y = y + kv * ssm_D[None, None, :]
        return q * y

    def _B_ref(x, dft_seq_re, dft_seq_im, dft_hid_re, dft_hid_im):
        a = torch.einsum("bsd,ed->bse", x, dft_hid_re)
        b = torch.einsum("bsd,ed->bse", x, dft_hid_im)
        y = torch.einsum("ts,bse->bte", dft_seq_re, a) - torch.einsum("ts,bse->bte", dft_seq_im, b)
        return y

    x = A_q
    g = _sigmoid((x * gate_w).sum(-1, keepdims=True))
    a = _A_ref(x, A_k, A_v, A_shift_k, A_ssm_k, A_ssm_D)
    b = _B_ref(x, B_dft_seq_re, B_dft_seq_im, B_dft_hid_re, B_dft_hid_im)
    return g * a + (1 - g) * b
```

```asm
; @launch grid=(256,1,1) block=(256,1,1) lds=104576
.amdgcn_target "amdgcn-amd-amdhsa--gfx950"
.text
.p2align 12
.fill 832, 4, 0xbf800000
.globl gated_mix__ssm_conv_h3__spectral_fnet__prompt_kernel
.p2align 8
.type gated_mix__ssm_conv_h3__spectral_fnet__prompt_kernel,@function
gated_mix__ssm_conv_h3__spectral_fnet__prompt_kernel:
    s_cmp_ge_u32 s2, 256
    s_cbranch_scc1 L_gated__end_1
    s_load_dwordx8 s[4:11], s[0:1], 0
    s_load_dwordx8 s[16:23], s[0:1], 88
    s_load_dwordx4 s[12:15], s[0:1], 32
    s_getpc_b64 s[24:25]
L_gated__pc_2:
    s_lshl_b32 s3, s2, 9
    s_and_b32 s3, s3, 0x3000
    v_lshl_add_u32 v2, v0, 4, s3
    v_min_u32 v2, L_gated__end_1-L_gated__pc_2, v2
    global_load_dword v1, v2, s[24:25]
    v_lshrrev_b32 v2, 6, v0
    s_and_b32 s24, s2, 7
    v_readfirstlane_b32 s26, v2
    s_bfe_u32 s28, s2, 0x40003
    v_and_b32 v2, 63, v0
    v_lshlrev_b32 v3, 4, v2
    s_lshl4_add_u32 s27, s24, s28
    s_sub_u32 s28, 256, s27
    s_cmp_eq_u32 s27, 0
    s_cselect_b32 s28, 128, s28
    s_cmp_lt_u32 s2, 128
    s_cselect_b32 s30, s27, s28
    s_and_b32 s27, s26, 2
    s_add_u32 s31, s26, s27
    s_lshl_b32 s27, s31, 8
    s_add_u32 s27, s27, s30
    s_lshl_b32 s27, s27, 10
    v_add_u32 v6, s27, v3
    s_sub_u32 s28, 2098160, s27
    s_bitset0_b32 s28, 21
    v_sub_u32 v7, s28, v3
    v_add_u32 v8, 524288, v6
    v_sub_u32 v9, 1573872, v6
    s_lshr_b32 s25, s2, 3
    v_and_b32 v4, 15, v0
    v_lshrrev_b32 v5, 4, v2
    v_and_b32 v70, 31, v0
    v_lshrrev_b32 v71, 5, v2
    s_lshl3_add_u32 s27, s25, s26
    s_lshl4_add_u32 s27, s27, 8
    s_lshl2_add_u32 s27, s27, s24
    s_lshl_b32 s27, s27, 7
    v_lshl_add_u32 v72, v71, 15, s27
    v_lshl_add_u32 v72, v70, 2, v72
    v_subrev_u32 v73, 7168, v72
    s_mov_b32 s38, 2097152
    s_mov_b32 s39, 0x00020000
    s_mov_b32 s42, 268435456
    s_mov_b32 s43, 0x00020000
    s_lshr_b32 s27, s2, 4
    s_lshl4_add_u32 s32, s24, s27
    s_and_b32 s33, s25, 1
    s_lshl_b32 s28, s24, 9
    v_lshl_add_u32 v74, v70, 4, s28
    s_lshl2_add_u32 s27, s32, s26
    s_lshl_b32 s28, s27, 12
    v_add_u32 v75, s28, v3
    v_lshrrev_b32 v76, 11, v75
    v_mul_u32_u24 v77, v5, v4
    v_cvt_f32_u32 v78, v4
    v_cvt_f32_u32 v77, v77
    v_mul_f32 v78, 0x3d000000, v78
    v_mul_f32 v77, 0x3e000000, v77
    s_mov_b32 s35, 0x80008000
    v_add_f32 v89, v78, v77
    v_add_f32 v90, v78, v89
    v_add_f32 v91, v78, v90
    v_cos_f32 v80, v77
    v_sin_f32 v88, v77
    v_cos_f32 v81, v89
    v_sin_f32 v89, v89
    v_cos_f32 v82, v90
    v_sin_f32 v90, v90
    s_waitcnt lgkmcnt(0)
    global_load_dwordx4 v[10:13], v6, s[4:5]
    s_mov_b32 s36, s6
    global_load_dwordx4 v[18:21], v7, s[4:5]
    s_and_b32 s37, s7, 0xffff
    global_load_dwordx4 v[14:17], v8, s[4:5]
    s_mov_b32 s40, s22
    global_load_dwordx4 v[22:25], v9, s[4:5]
    s_and_b32 s41, s23, 0xffff
    s_cmp_ge_u32 s2, 4
    s_cbranch_scc1 L_gated__noclear_5
    s_lshl_b32 s3, s2, 12
    s_add_u32 s3, s3, 6356992
    v_lshl_add_u32 v6, v0, 4, s3
    v_pk_mov_b32 v[66:67], 0, 0
    v_pk_mov_b32 v[68:69], 0, 0
    global_store_dwordx4 v6, v[66:69], s[22:23] sc1
L_gated__noclear_5:
    global_load_dwordx4 v[46:49], v3, s[16:17]
    v_cos_f32 v83, v91
    v_sin_f32 v91, v91
    v_bfe_i32 v79, v0, 0, 1
    v_and_b32 v79, s35, v79
    v_cvt_pk_bf16_f32 v96, v80, v81
    v_cvt_pk_bf16_f32 v104, v88, v89
    v_cvt_pk_bf16_f32 v97, v82, v83
    v_cvt_pk_bf16_f32 v105, v90, v91
    v_xor_b32 v98, v79, v96
    v_xor_b32 v106, v79, v104
    v_xor_b32 v99, v79, v97
    v_xor_b32 v107, v79, v105
    v_lshrrev_b32 v112, 2, v4
    v_lshl_add_u32 v79, s26, 2, v112
    v_mul_u32_u24 v113, v5, v79
    v_cvt_f32_u32 v78, v79
    v_cvt_f32_u32 v77, v113
    v_mul_f32 v78, 0x3b000000, v78
    v_mul_f32 v77, 0x3c000000, v77
    v_add_f32 v89, v78, v77
    v_add_f32 v90, v78, v89
    v_add_f32 v91, v78, v90
    v_fmamk_f32 v92, v78, 0x41800000, v77
    v_add_f32 v93, v78, v92
    v_add_f32 v94, v78, v93
    v_add_f32 v95, v78, v94
    v_cos_f32 v80, v77
    v_sin_f32 v88, v77
    v_cos_f32 v81, v89
    v_sin_f32 v89, v89
    v_cos_f32 v82, v90
    v_sin_f32 v90, v90
    v_cos_f32 v83, v91
    v_sin_f32 v91, v91
    v_cos_f32 v84, v92
    v_sin_f32 v92, v92
    v_cos_f32 v85, v93
    v_sin_f32 v93, v93
    v_cos_f32 v86, v94
    v_sin_f32 v94, v94
    v_cos_f32 v87, v95
    v_sin_f32 v95, v95
    s_and_b32 s28, s26, 1
    s_mul_i32 s27, s31, 40
    s_add_u32 s27, s27, s28
    v_lshl_add_u32 v116, s27, 5, v3
    v_bfe_u32 v114, v0, 2, 2
    v_and_b32 v115, 8, v0
    v_mul_u32_u24 v117, 1312, v114
    v_and_or_b32 v115, v0, 3, v115
    v_lshl_add_u32 v115, v5, 3, v115
    v_lshl_add_u32 v117, v115, 3, v117
    s_lshr_b32 s27, s26, 1
    s_lshl1_add_u32 s27, s28, s27
    s_lshl_b32 s27, s27, 9
    s_add_u32 s27, s27, 68736
    v_lshl_add_u32 v118, v2, 2, s27
    s_mov_b32 s28, 68736
    v_lshl_add_u32 v119, v2, 5, s28
    s_lshl4_add_u32 s27, s26, 2048
    s_lshl4_add_u32 s27, s27, s30
    s_lshl_b32 s27, s27, 6
    v_lshl_add_u32 v120, v5, 4, s27
    v_lshl_add_u32 v121, v4, 16, v120
    v_and_b32 v123, 0xcf, v0
    v_cmp_eq_u32 s[44:45], 0, v123
    v_add_u32 v120, 1048576, v120
    s_and_b32 s27, s30, 1
    v_cndmask_b32 v122, 2.0, v120, s[44:45]
    s_mul_i32 s27, s27, 255
    s_add_u32 s27, s27, s30
    s_lshl4_add_u32 s27, s27, 3145728
    v_and_b32 v120, 0xc6, v0
    v_cmp_eq_u32 s[44:45], 0, v120
    v_and_b32 v120, 1, v0
    v_lshl_add_u32 v124, v120, 4, s27
    v_lshrrev_b32 v123, 2, v0
    v_add_lshl_u32 v124, v124, v123, 1
    v_cndmask_b32 v124, 2.0, v124, s[44:45]
    s_lshl_b32 s27, s24, 9
    s_add_u32 s27, s27, s25
    s_lshl2_add_u32 s27, s27, s26
    s_lshl_b32 s27, s27, 7
    v_lshl_add_u32 v120, v71, 1, v120
    v_lshl_add_u32 v120, v120, 4, s27
    buffer_load_dword v26, v73, s[36:39], 0 offen offset:0
    v_lshrrev_b32 v123, 1, v70
    v_lshl_add_u32 v123, v123, 14, v120
    buffer_load_dword v27, v73, s[36:39], 0 offen offset:1024
    s_movk_i32 s46, 0x3f80
    s_movk_i32 s48, 0x3f80
    buffer_load_dword v28, v73, s[36:39], 0 offen offset:2048
    s_lshr_b32 s27, s30, 7
    s_mul_i32 s51, s27, s35
    global_load_dword v29, v72, s[6:7] offset:-4096
    s_lshl_b32 s27, s27, 1
    s_mov_b32 s29, 0
    global_load_dword v30, v72, s[6:7] offset:-3072
    s_and_b32 s50, s30, 127
    s_cbranch_scc1 L_gated__nospecial_3
    s_lshl_b32 s27, s31, 8
    s_add_u32 s27, s27, s30
    v_cvt_f32_u32 v126, s27
    v_mul_f32 v126, 0x39800000, v126
    v_sub_f32 v127, 0x3e000000, v126
    v_cos_f32 v126, v126
    v_cos_f32 v127, v127
    s_mov_b32 s27, 1
    v_cvt_pk_bf16_f32 v126, v127, v126
    s_movk_i32 s29, 3584
    v_readfirstlane_b32 s48, v126
    s_nop 1
    s_and_b32 s46, s48, 0xffff
    s_lshr_b32 s48, s48, 16
L_gated__nospecial_3:
    global_load_dword v31, v72, s[6:7] offset:-2048
    s_lshl_b32 s47, s46, 16
    s_lshl_b32 s49, s48, 16
    global_load_dword v32, v72, s[6:7] offset:-1024
    v_and_b32 v125, 3, v0
    v_lshl_add_u32 v125, v125, 2, s27
    global_load_dword v33, v72, s[6:7] offset:0
    v_lshl_add_u32 v126, v113, 8, s29
    v_mad_u32_u24 v126, v125, s30, v126
    global_load_dword v34, v72, s[6:7] offset:1024
    v_cvt_f32_u32 v127, v125
    v_cvt_f32_u32 v126, v126
    global_load_dword v35, v72, s[6:7] offset:2048
    v_mul_f32 v127, 0xbd800000, v127
    v_mul_f32 v126, 0xb9800000, v126
    global_load_dword v36, v72, s[6:7] offset:3072
    v_add_f32 v133, v127, v126
    v_add_f32 v134, v127, v133
    global_load_dwordx4 v[50:53], v74, s[10:11]
    v_add_f32 v135, v127, v134
    v_cos_f32 v128, v126
    global_load_dword v37, v72, s[8:9] offset:-4096
    v_sin_f32 v132, v126
    v_cos_f32 v129, v133
    global_load_dword v38, v72, s[8:9] offset:-3072
    v_sin_f32 v133, v133
    v_cos_f32 v130, v134
    global_load_dword v39, v72, s[8:9] offset:-2048
    v_sin_f32 v134, v134
    v_cos_f32 v131, v135
    global_load_dword v40, v72, s[8:9] offset:-1024
    v_sin_f32 v135, v135
    v_bfe_i32 v125, v0, 2, 1
    global_load_dword v41, v72, s[8:9] offset:0
    v_bfe_i32 v126, v0, 3, 1
    v_cvt_pk_bf16_f32 v136, v128, v129
    global_load_dword v42, v72, s[8:9] offset:1024
    v_cvt_pk_bf16_f32 v152, v132, v133
    v_cvt_pk_bf16_f32 v137, v130, v131
    global_load_dword v43, v72, s[8:9] offset:2048
    v_cvt_pk_bf16_f32 v153, v134, v135
    s_mov_b32 s52, 0xf0f0f0f0
    global_load_dword v44, v72, s[8:9] offset:3072
    s_mov_b32 s53, s52
    v_and_b32 v125, s35, v125
    v_and_b32 v126, s35, v126
    v_xor_b32 v127, v125, v126
    v_xor_b32 v138, s51, v136
    v_xor_b32 v154, s51, v152
    v_xor_b32 v139, s51, v137
    v_xor_b32 v155, s51, v153
    s_cmp_lg_u32 s50, 0
    s_cbranch_scc1 L_gated__nospecial_4
    v_mov_b32 v138, v152
    v_xor_b32 v154, s35, v136
    v_mov_b32 v139, v153
    v_xor_b32 v155, s35, v137
L_gated__nospecial_4:
    v_cndmask_b32 v148, v136, v152, s[52:53]
    v_cndmask_b32 v164, v152, v136, s[52:53]
    v_xor_b32 v144, v136, v125
    v_xor_b32 v160, v152, v125
    v_cndmask_b32 v149, v137, v153, s[52:53]
    v_cndmask_b32 v165, v153, v137, s[52:53]
    v_xor_b32 v145, v137, v125
    v_xor_b32 v161, v153, v125
    v_cndmask_b32 v150, v138, v154, s[52:53]
    v_cndmask_b32 v166, v154, v138, s[52:53]
    v_xor_b32 v146, v138, v125
    v_xor_b32 v162, v154, v125
    v_cndmask_b32 v151, v139, v155, s[52:53]
    v_cndmask_b32 v167, v155, v139, s[52:53]
    v_xor_b32 v147, v139, v125
    v_xor_b32 v163, v155, v125
    v_xor_b32 v140, v148, v126
    v_xor_b32 v156, v164, v127
    v_xor_b32 v148, v148, v127
    v_xor_b32 v164, v164, v126
    v_xor_b32 v141, v149, v126
    v_xor_b32 v157, v165, v127
    v_xor_b32 v149, v149, v127
    v_xor_b32 v165, v165, v126
    v_xor_b32 v142, v150, v126
    v_xor_b32 v158, v166, v127
    v_xor_b32 v150, v150, v127
    v_xor_b32 v166, v166, v126
    v_xor_b32 v143, v151, v126
    v_xor_b32 v159, v167, v127
    v_xor_b32 v151, v151, v127
    v_xor_b32 v167, v167, v126
    s_mov_b32 s34, 0xffff0000
    global_load_dwordx4 v[54:57], v75, s[12:13] offset:0
    global_load_dwordx4 v[58:61], v75, s[12:13] offset:1024
    global_load_ushort v45, v76, s[14:15]
    s_mul_i32 s27, s26, 8448
    s_add_u32 s27, s27, 70784
    v_lshl_add_u32 v6, v4, 2, s27
    v_add_u32 v8, s27, v3
    v_mov_b32 v7, 0
    s_lshl_b32 s36, s33, 4
    s_xor_b32 s36, s36, 16
    ds_write_b32 v6, v7
    ds_write_b32 v6, v7 offset:4224
    s_add_u32 s28, s33, 1
    v_lshl_add_u32 v6, v5, 2, v4
    v_add_u32 v6, s28, v6
    v_and_b32 v7, 1, v6
    v_mul_u32_u24 v7, 4220, v7
    v_lshl_add_u32 v6, v6, 2, s27
    v_add_u32 v9, v7, v6
    s_and_b32 s27, s25, 15
    s_lshl_b32 s27, s27, 7
    s_add_u32 s27, s27, 6356992
    v_cmp_gt_u32 s[38:39], 8, v0
    v_lshl_add_u32 v6, v0, 11, s27
    s_and_b32 s27, s24, 7
    s_lshl_b32 s27, s27, 11
    s_add_u32 s27, s27, 6356992
    v_cndmask_b32 v6, 2.0, v6, s[38:39]
    v_lshl_add_u32 v7, v4, 7, s27
    v_mov_b32 v70, 1
    s_waitcnt vmcnt(27)
    v_dot2_f32_bf16 v126, v10, s46, 0
    v_dot2_f32_bf16 v127, v10, s47, 0
    v_dot2_f32_bf16 v128, v11, s46, 0
    v_dot2_f32_bf16 v129, v11, s47, 0
    v_dot2_f32_bf16 v130, v12, s46, 0
    v_dot2_f32_bf16 v131, v12, s47, 0
    v_dot2_f32_bf16 v132, v13, s46, 0
    v_dot2_f32_bf16 v133, v13, s47, 0
    s_waitcnt vmcnt(26)
    v_mov_b32_dpp v71, v18 wave_ror:1 row_mask:0xf bank_mask:0xf
    v_dot2c_f32_bf16 v126, s46, v71
    v_dot2c_f32_bf16 v127, s47, v21
    v_dot2c_f32_bf16 v128, s46, v21
    v_dot2c_f32_bf16 v129, s47, v20
    v_dot2c_f32_bf16 v130, s46, v20
    v_dot2c_f32_bf16 v131, s47, v19
    v_dot2c_f32_bf16 v132, s46, v19
    v_dot2c_f32_bf16 v133, s47, v18
    v_cvt_pk_bf16_f32 v76, v126, v127
    v_cvt_pk_bf16_f32 v77, v128, v129
    v_cvt_pk_bf16_f32 v78, v130, v131
    v_cvt_pk_bf16_f32 v79, v132, v133
    ds_write_b128 v116, v[76:79] offset:0
    s_waitcnt vmcnt(25)
    v_dot2_f32_bf16 v126, v14, s48, 0
    v_dot2_f32_bf16 v127, v14, s49, 0
    v_dot2_f32_bf16 v128, v15, s48, 0
    v_dot2_f32_bf16 v129, v15, s49, 0
    v_dot2_f32_bf16 v130, v16, s48, 0
    v_dot2_f32_bf16 v131, v16, s49, 0
    v_dot2_f32_bf16 v132, v17, s48, 0
    v_dot2_f32_bf16 v133, v17, s49, 0
    s_waitcnt vmcnt(24)
    v_mov_b32_dpp v71, v22 wave_ror:1 row_mask:0xf bank_mask:0xf
    v_dot2c_f32_bf16 v126, s48, v71
    v_dot2c_f32_bf16 v127, s49, v25
    v_dot2c_f32_bf16 v128, s48, v25
    v_dot2c_f32_bf16 v129, s49, v24
    v_dot2c_f32_bf16 v130, s48, v24
    v_dot2c_f32_bf16 v131, s49, v23
    v_dot2c_f32_bf16 v132, s48, v23
    v_dot2c_f32_bf16 v133, s49, v22
    v_cvt_pk_bf16_f32 v18, v126, v127
    v_cvt_pk_bf16_f32 v19, v128, v129
    v_cvt_pk_bf16_f32 v20, v130, v131
    v_cvt_pk_bf16_f32 v21, v132, v133
    ds_write_b128 v116, v[18:21] offset:2688
    s_waitcnt vmcnt(23)
    v_dot2_f32_bf16 v126, v10, v46, 0
    v_dot2_f32_bf16 v127, v14, v46, 0
    v_dot2_f32_bf16 v126, v11, v47, v126
    v_dot2_f32_bf16 v127, v15, v47, v127
    v_dot2_f32_bf16 v126, v12, v48, v126
    v_dot2_f32_bf16 v127, v16, v48, v127
    v_dot2_f32_bf16 v126, v13, v49, v126
    v_dot2_f32_bf16 v127, v17, v49, v127
    s_waitcnt lgkmcnt(0)
    s_barrier
    ds_read_b64_tr_b16 v[10:11], v117 offset:0
    ds_read_b64_tr_b16 v[12:13], v117 offset:5120
    ds_read_b64_tr_b16 v[14:15], v117 offset:256
    ds_read_b64_tr_b16 v[16:17], v117 offset:5376
    ds_read_b64_tr_b16 v[18:19], v117 offset:512
    ds_read_b64_tr_b16 v[20:21], v117 offset:5632
    ds_read_b64_tr_b16 v[22:23], v117 offset:768
    ds_read_b64_tr_b16 v[24:25], v117 offset:5888
    ds_write2st64_b32 v118, v126, v127 offset0:0 offset1:1
    s_lshl2_add_u32 s27, s26, s2
    s_cmp_ge_u32 s27, 4
    s_cbranch_scc1 L_gated__nogo_6
    s_lshl_b32 s27, s2, 6
    v_lshl_add_u32 v71, v4, 2, s27
    v_mov_b32 v72, 1
    s_mov_b64 exec, 0xffff
    global_store_dword v71, v72, s[20:21] sc1
    s_mov_b64 exec, -1
L_gated__nogo_6:
    s_waitcnt lgkmcnt(7)
    v_mfma_f32_16x16x32_bf16 v[172:175], v[10:13], v[136:139], 0
    ds_read_b64_tr_b16 v[46:47], v117 offset:32
    v_xor_b32 v108, s35, v104
    v_mfma_f32_16x16x32_bf16 v[180:183], v[10:13], v[152:155], 0
    s_waitcnt lgkmcnt(6)
    ds_read_b64_tr_b16 v[48:49], v117 offset:5152
    v_xor_b32 v109, s35, v105
    v_mfma_f32_16x16x32_bf16 v[172:175], v[14:17], v[140:143], v[172:175]
    ds_read_b64_tr_b16 v[76:77], v117 offset:288
    v_xor_b32 v110, s35, v106
    v_mfma_f32_16x16x32_bf16 v[180:183], v[14:17], v[156:159], v[180:183]
    s_waitcnt lgkmcnt(6)
    ds_read_b64_tr_b16 v[78:79], v117 offset:5408
    v_xor_b32 v111, s35, v107
    v_mfma_f32_16x16x32_bf16 v[172:175], v[18:21], v[144:147], v[172:175]
    ds_read_b64_tr_b16 v[112:113], v117 offset:544
    v_mov_b32 v100, 0xbf803f80
    v_mfma_f32_16x16x32_bf16 v[180:183], v[18:21], v[160:163], v[180:183]
    s_waitcnt lgkmcnt(5)
    ds_read_b64_tr_b16 v[114:115], v117 offset:5664
    v_mov_b32 v101, v100
    v_mfma_f32_16x16x32_bf16 v[172:175], v[22:25], v[148:151], v[172:175]
    s_barrier
    ds_read_b64_tr_b16 v[168:169], v117 offset:800
    v_mov_b32 v102, v100
    v_mfma_f32_16x16x32_bf16 v[180:183], v[22:25], v[164:167], v[180:183]
    s_waitcnt lgkmcnt(5)
    ds_read_b64_tr_b16 v[170:171], v117 offset:5920
    v_mov_b32 v103, v100
    v_mfma_f32_16x16x32_bf16 v[176:179], v[46:49], v[136:139], 0
    ds_read_b128 v[126:129], v119 offset:0
    v_mfma_f32_16x16x32_bf16 v[184:187], v[46:49], v[152:155], 0
    s_waitcnt lgkmcnt(5)
    ds_read_b128 v[130:133], v119 offset:16
    v_mfma_f32_16x16x32_bf16 v[176:179], v[76:79], v[140:143], v[176:179]
    s_waitcnt vmcnt(22)
    v_lshlrev_b32 v72, 16, v26
    v_and_b32 v73, s34, v26
    v_mfma_f32_16x16x32_bf16 v[184:187], v[76:79], v[156:159], v[184:187]
    s_waitcnt vmcnt(21) lgkmcnt(4)
    v_lshlrev_b32 v134, 16, v27
    v_and_b32 v135, s34, v27
    v_mfma_f32_16x16x32_bf16 v[176:179], v[112:115], v[144:147], v[176:179]
    s_waitcnt vmcnt(20)
    v_lshlrev_b32 v200, 16, v28
    v_and_b32 v201, s34, v28
    v_mfma_f32_16x16x32_bf16 v[184:187], v[112:115], v[160:163], v[184:187]
    s_waitcnt lgkmcnt(0)
    v_add_f32 v126, v126, v130
    v_add_f32 v127, v127, v131
    v_mfma_f32_16x16x32_bf16 v[176:179], v[168:171], v[148:151], v[176:179]
    v_add_f32 v128, v128, v132
    v_add_f32 v129, v129, v133
    v_mfma_f32_16x16x32_bf16 v[184:187], v[168:171], v[164:167], v[184:187]
    v_add_f32 v126, v126, v128
    v_add_f32 v127, v127, v129
    v_pk_mul_f32 v[196:197], v[180:181], v[88:89]
    v_pk_mul_f32 v[180:181], v[180:181], v[80:81]
    v_pk_mul_f32 v[198:199], v[182:183], v[90:91]
    v_pk_mul_f32 v[182:183], v[182:183], v[82:83]
    v_pk_fma_f32 v[180:181], v[172:173], v[88:89], v[180:181] neg_lo:[1,0,0] neg_hi:[1,0,0]
    v_pk_fma_f32 v[172:173], v[172:173], v[80:81], v[196:197]
    v_pk_fma_f32 v[182:183], v[174:175], v[90:91], v[182:183] neg_lo:[1,0,0] neg_hi:[1,0,0]
    v_pk_fma_f32 v[174:175], v[174:175], v[82:83], v[198:199]
    v_cvt_pk_bf16_f32 v192, v180, v181
    v_cvt_pk_bf16_f32 v193, v182, v183
    v_cvt_pk_bf16_f32 v188, v172, v173
    v_cvt_pk_bf16_f32 v189, v174, v175
    v_pk_mul_f32 v[196:197], v[184:185], v[92:93]
    v_pk_mul_f32 v[184:185], v[184:185], v[84:85]
    v_pk_mul_f32 v[198:199], v[186:187], v[94:95]
    v_pk_mul_f32 v[186:187], v[186:187], v[86:87]
    v_pk_fma_f32 v[184:185], v[176:177], v[92:93], v[184:185] neg_lo:[1,0,0] neg_hi:[1,0,0]
    v_pk_fma_f32 v[176:177], v[176:177], v[84:85], v[196:197]
    v_pk_fma_f32 v[186:187], v[178:179], v[94:95], v[186:187] neg_lo:[1,0,0] neg_hi:[1,0,0]
    v_pk_fma_f32 v[178:179], v[178:179], v[86:87], v[198:199]
    v_cvt_pk_bf16_f32 v194, v184, v185
    v_cvt_pk_bf16_f32 v195, v186, v187
    v_cvt_pk_bf16_f32 v190, v176, v177
    v_cvt_pk_bf16_f32 v191, v178, v179
    v_mfma_f32_16x16x32_bf16 v[10:13], v[192:195], v[104:107], 0
    s_waitcnt vmcnt(19)
    v_add_f32 v126, v126, v127
    v_lshlrev_b32 v202, 16, v29
    v_mfma_f32_16x16x32_bf16 v[18:21], v[192:195], v[96:99], 0
    v_add_f32_dpp v126, v126, v126 quad_perm:[1,0,3,2] row_mask:0xf bank_mask:0xf
    v_and_b32 v203, s34, v29
    v_mfma_f32_16x16x32_bf16 v[10:13], v[188:191], v[96:99], v[10:13]
    s_waitcnt vmcnt(18)
    v_add_f32_dpp v126, v126, v126 quad_perm:[2,3,0,1] row_mask:0xf bank_mask:0xf
    v_lshlrev_b32 v204, 16, v30
    v_mfma_f32_16x16x32_bf16 v[18:21], v[188:191], v[108:111], v[18:21]
    v_add_f32_dpp v126, v126, v126 row_half_mirror row_mask:0xf bank_mask:0xf
    v_and_b32 v205, s34, v30
    v_mfma_f32_16x16x32_bf16 v[22:25], v[192:195], v[100:103], 0
    s_waitcnt vmcnt(17)
    v_mul_f32 v126, 0xbfb8aa3b, v126
    v_lshlrev_b32 v206, 16, v31
    v_mfma_f32_16x16x32_bf16 v[14:17], v[188:191], v[100:103], 0
    v_exp_f32 v126, v126
    s_nop 0
    v_add_f32 v126, 1.0, v126
    v_rcp_f32 v126, v126
    v_and_b32 v207, s34, v31
    s_waitcnt vmcnt(16)
    v_lshlrev_b32 v208, 16, v32
    v_cvt_pk_bf16_f32 v46, v10, v18
    v_cvt_pk_bf16_f32 v47, v11, v19
    v_cvt_pk_bf16_f32 v48, v12, v20
    v_cvt_pk_bf16_f32 v49, v13, v21
    v_cvt_pk_bf16_f32 v76, v14, v22
    v_cvt_pk_bf16_f32 v77, v15, v23
    v_cvt_pk_bf16_f32 v78, v16, v24
    v_cvt_pk_bf16_f32 v79, v17, v25
    v_and_b32 v209, s34, v32
    s_waitcnt vmcnt(15)
    v_lshlrev_b32 v210, 16, v33
    v_and_b32 v211, s34, v33
    s_waitcnt vmcnt(14)
    v_lshlrev_b32 v212, 16, v34
    v_and_b32 v213, s34, v34
    s_waitcnt vmcnt(13)
    v_lshlrev_b32 v214, 16, v35
    v_and_b32 v215, s34, v35
    s_waitcnt vmcnt(12)
    v_lshlrev_b32 v216, 16, v36
    v_and_b32 v217, s34, v36
    s_waitcnt vmcnt(11)
    v_lshlrev_b32 v218, 16, v50
    v_and_b32 v220, s34, v50
    v_lshlrev_b32 v222, 16, v51
    v_and_b32 v224, s34, v51
    v_lshlrev_b32 v219, 16, v52
    v_and_b32 v221, s34, v52
    v_lshlrev_b32 v223, 16, v53
    v_and_b32 v225, s34, v53
    v_pk_mul_f32 v[84:85], v[202:203], v[218:219]
    v_pk_mul_f32 v[86:87], v[204:205], v[218:219]
    v_pk_mul_f32 v[88:89], v[206:207], v[218:219]
    v_pk_mul_f32 v[90:91], v[208:209], v[218:219]
    v_pk_mul_f32 v[92:93], v[210:211], v[218:219]
    v_pk_mul_f32 v[94:95], v[212:213], v[218:219]
    v_pk_mul_f32 v[96:97], v[214:215], v[218:219]
    v_pk_mul_f32 v[98:99], v[216:217], v[218:219]
    v_pk_fma_f32 v[84:85], v[200:201], v[220:221], v[84:85]
    v_pk_fma_f32 v[86:87], v[202:203], v[220:221], v[86:87]
    v_pk_fma_f32 v[88:89], v[204:205], v[220:221], v[88:89]
    v_pk_fma_f32 v[90:91], v[206:207], v[220:221], v[90:91]
    v_pk_fma_f32 v[92:93], v[208:209], v[220:221], v[92:93]
    v_pk_fma_f32 v[94:95], v[210:211], v[220:221], v[94:95]
    v_pk_fma_f32 v[96:97], v[212:213], v[220:221], v[96:97]
    v_pk_fma_f32 v[98:99], v[214:215], v[220:221], v[98:99]
    v_pk_fma_f32 v[84:85], v[134:135], v[222:223], v[84:85]
    v_pk_fma_f32 v[86:87], v[200:201], v[222:223], v[86:87]
    v_pk_fma_f32 v[88:89], v[202:203], v[222:223], v[88:89]
    v_pk_fma_f32 v[90:91], v[204:205], v[222:223], v[90:91]
    v_pk_fma_f32 v[92:93], v[206:207], v[222:223], v[92:93]
    v_pk_fma_f32 v[94:95], v[208:209], v[222:223], v[94:95]
    v_pk_fma_f32 v[96:97], v[210:211], v[222:223], v[96:97]
    v_pk_fma_f32 v[98:99], v[212:213], v[222:223], v[98:99]
    v_pk_fma_f32 v[84:85], v[72:73], v[224:225], v[84:85]
    v_pk_fma_f32 v[86:87], v[134:135], v[224:225], v[86:87]
    v_pk_fma_f32 v[88:89], v[200:201], v[224:225], v[88:89]
    v_pk_fma_f32 v[90:91], v[202:203], v[224:225], v[90:91]
    v_pk_fma_f32 v[92:93], v[204:205], v[224:225], v[92:93]
    v_pk_fma_f32 v[94:95], v[206:207], v[224:225], v[94:95]
    v_pk_fma_f32 v[96:97], v[208:209], v[224:225], v[96:97]
    v_pk_fma_f32 v[98:99], v[210:211], v[224:225], v[98:99]
    s_waitcnt vmcnt(3)
    buffer_store_dwordx4 v[46:49], v121, s[40:43], 0 offen sc1
    v_lshlrev_b32 v82, 16, v44
    v_and_b32 v83, s34, v44
    v_lshlrev_b32 v80, 16, v43
    v_and_b32 v81, s34, v43
    v_lshlrev_b32 v24, 16, v42
    v_and_b32 v25, s34, v42
    buffer_store_dwordx4 v[76:79], v122, s[40:43], 0 offen sc1
    v_lshlrev_b32 v22, 16, v41
    v_and_b32 v23, s34, v41
    v_lshlrev_b32 v20, 16, v40
    v_and_b32 v21, s34, v40
    v_lshlrev_b32 v18, 16, v39
    v_and_b32 v19, s34, v39
    buffer_store_dword v126, v124, s[40:43], 0 offen sc1
    v_lshlrev_b32 v16, 16, v38
    v_and_b32 v17, s34, v38
    v_lshlrev_b32 v14, 16, v37
    v_and_b32_e64 v15, s34, v37
    v_pk_mul_f32 v[98:99], v[98:99], v[82:83]
    v_pk_mul_f32 v[96:97], v[96:97], v[80:81]
    v_pk_mul_f32 v[94:95], v[94:95], v[24:25]
    v_pk_mul_f32 v[92:93], v[92:93], v[22:23]
    v_pk_mul_f32 v[90:91], v[90:91], v[20:21]
    v_pk_mul_f32 v[88:89], v[88:89], v[18:19]
    v_pk_mul_f32 v[86:87], v[86:87], v[16:17]
    v_pk_mul_f32 v[84:85], v[84:85], v[14:15]
    v_cvt_pk_bf16_f32 v100, v98, v96
    v_cvt_pk_bf16_f32 v101, v94, v92
    v_cvt_pk_bf16_f32 v102, v90, v88
    v_cvt_pk_bf16_f32 v103, v86, v84
    global_store_dwordx4 v123, v[100:103], s[22:23] offset:0 sc1
    v_cvt_pk_bf16_f32 v104, v99, v97
    v_cvt_pk_bf16_f32 v105, v95, v93
    v_cvt_pk_bf16_f32 v106, v91, v89
    v_cvt_pk_bf16_f32 v107, v87, v85
    global_store_dwordx4 v123, v[104:107], s[22:23] offset:64 sc1
    v_lshlrev_b32 v14, 6, v5
    global_load_dword v1, v14, s[20:21] sc1
    s_waitcnt vmcnt(7)
    s_mov_b64 exec, 1
    s_waitcnt vmcnt(6)
    v_lshlrev_b32 v45, 16, v45
    v_lshlrev_b32 v108, 16, v54
    v_add_f32 v108, v108, v45
    v_and_b32_e64 v54, s34, v54
    v_cvt_pk_bf16_f32 v54, v108, v54
    s_mov_b64 exec, -1
    v_mov_b32_dpp v11, v57 wave_ror:1 row_mask:0xf bank_mask:0xf
    v_mov_b32_dpp v12, v61 wave_ror:1 row_mask:0xf bank_mask:0xf
    v_mov_b32_dpp v10, v57 wave_shr:1 row_mask:0xf bank_mask:0xf bound_ctrl:0
    v_mov_b32_dpp v11, v61 wave_shr:1 row_mask:0xf bank_mask:0xf
    v_alignbit_b32 v109, v55, v54, s36
    v_alignbit_b32 v110, v56, v55, s36
    v_alignbit_b32 v111, v57, v56, s36
    v_alignbit_b32 v108, v54, v10, s36
    ds_write_b128 v8, v[108:111] offset:64
    v_alignbit_b32 v113, v59, v58, s36
    v_alignbit_b32 v114, v60, v59, s36
    v_alignbit_b32 v115, v61, v60, s36
    v_alignbit_b32 v112, v58, v11, s36
    ds_write_b128 v8, v[112:115] offset:1088
    s_cmp_eq_u32 s33, 1
    s_cbranch_scc1 L_gated__noshift_7
    v_mov_b32_dpp v57, v112 wave_rol:1 row_mask:0xf bank_mask:0xf
    v_pk_mov_b32 v[54:55], v[108:109], v[110:111] op_sel:[1,0]
    v_mov_b32 v56, v111
    v_pk_mov_b32 v[58:59], v[112:113], v[114:115] op_sel:[1,0]
    v_mov_b32 v60, v115
    v_mov_b32_dpp v57, v108 wave_shl:1 row_mask:0xf bank_mask:0xf
    v_mov_b32_dpp v61, v112 wave_shl:1 row_mask:0xf bank_mask:0xf
L_gated__noshift_7:
    ds_write_b32 v8, v108 offset:4284
    ds_write_b128 v8, v[54:57] offset:4288
    ds_write_b128 v8, v[58:61] offset:5312
    global_load_dwordx4 v[62:65], v75, s[12:13] offset:2048
    global_load_dwordx4 v[66:69], v75, s[12:13] offset:3072
    ds_read_b64 a[0:1], v9 offset:0
    ds_read_b64 a[2:3], v9 offset:8
    ds_read_b64 a[4:5], v9 offset:64
    ds_read_b64 a[6:7], v9 offset:72
    ds_read_b64 a[8:9], v9 offset:128
    ds_read_b64 a[10:11], v9 offset:136
    ds_read_b64 a[12:13], v9 offset:192
    ds_read_b64 a[14:15], v9 offset:200
    s_lshl_b32 s35, s26, 2
    v_and_b32 v25, 60, v0
    v_lshl_add_u32 v15, v25, 2, s35
    v_and_or_b32 v15, v0, 3, v15
    s_lshl_b32 s35, s33, 7
    s_add_u32 s35, s35, s32
    s_lshl_b32 s35, s35, 3
    v_lshl_add_u32 v24, v15, 11, s35
    ds_read_b64 a[16:17], v9 offset:256
    ds_read_b64 a[18:19], v9 offset:264
    ds_read_b64 a[20:21], v9 offset:320
    ds_read_b64 a[22:23], v9 offset:328
    ds_read_b64 a[24:25], v9 offset:384
    ds_read_b64 a[26:27], v9 offset:392
    ds_read_b64 a[28:29], v9 offset:448
    ds_read_b64 a[30:31], v9 offset:456
    s_mov_b32 s44, s4
    s_and_b32 s45, s5, 0xffff
    s_mov_b32 s46, 2097152
    s_mov_b32 s47, 0x00020000
    s_mov_b32 s48, 524288
    s_mov_b32 s49, 1048576
    s_mov_b32 s50, 1572864
    s_mov_b32 s52, s18
    ds_read_b64 a[32:33], v9 offset:512
    ds_read_b64 a[34:35], v9 offset:520
    ds_read_b64 a[36:37], v9 offset:576
    ds_read_b64 a[38:39], v9 offset:584
    ds_read_b64 a[40:41], v9 offset:640
    ds_read_b64 a[42:43], v9 offset:648
    ds_read_b64 a[44:45], v9 offset:704
    ds_read_b64 a[46:47], v9 offset:712
    s_and_b32 s53, s19, 0xffff
    s_mov_b32 s54, 2097152
    s_mov_b32 s55, 0x00020000
    s_lshl_b32 s51, s32, 14
    s_add_u32 s35, s51, 4096
    v_lshl_add_u32 v28, v0, 4, s35
    v_add_u32 v29, 8192, v28
    v_and_b32 v26, 1, v0
    ds_read_b64 a[48:49], v9 offset:768
    ds_read_b64 a[50:51], v9 offset:776
    ds_read_b64 a[52:53], v9 offset:832
    ds_read_b64 a[54:55], v9 offset:840
    ds_read_b64 a[56:57], v9 offset:896
    ds_read_b64 a[58:59], v9 offset:904
    ds_read_b64 a[60:61], v9 offset:960
    ds_read_b64 a[62:63], v9 offset:968
    v_bfe_u32 v27, v0, 2, 1
    v_lshl_add_u32 v26, v26, 1, v27
    v_mul_u32_u24 v30, 5152, v26
    v_bfe_u32 v26, v0, 3, 2
    v_xor_b32 v26, 3, v26
    v_mul_u32_u24 v26, 1280, v26
    v_and_b32 v27, 0xe0, v0
    v_add3_u32 v30, v30, v26, v27
    v_and_b32 v26, 2, v0
    v_lshl_add_u32 v30, v26, 3, v30
    s_add_u32 s35, s32, 63
    s_lshr_b32 s56, s35, 7
    s_lshl2_add_u32 s35, s32, s26
    s_lshl1_add_u32 s37, s35, -512
    s_mul_i32 s37, s37, s56
    s_sub_u32 s35, s35, s37
    s_and_b32 s37, s35, 3
    s_lshr_b32 s35, s35, 2
    s_lshl_b32 s35, s35, 14
    s_lshl4_add_u32 s35, s37, s35
    s_add_u32 s35, s35, 2097152
    v_mov_b32 v34, s35
    v_add_u32 v35, 8192, v34
    v_cmp_eq_u32 s[38:39], 0, v2
    s_waitcnt vmcnt(2)
    v_cmp_eq_u32 vcc, 0, v1
    s_mov_b32 s28, 0
    s_cbranch_vccz L_gated__gook_8
L_gated__gospin_9:
    global_load_dword v1, v14, s[20:21] sc1
    s_add_u32 s28, s28, 1
    s_lshr_b32 s29, s28, 20
    s_waitcnt vmcnt(0)
    v_or_b32 v1, s29, v1
    v_cmp_eq_u32 vcc, 0, v1
    s_cbranch_vccnz L_gated__gospin_9
L_gated__gook_8:
    s_barrier
    buffer_atomic_add v70, v6, s[40:43], 0 offen sc1
    s_lshl_b32 s27, s25, 2
    s_add_u32 s27, s27, s26
    s_lshl_b32 s27, s27, 7
    s_add_u32 s27, s27, s24
    s_lshl_b32 s27, s27, 7
    v_lshl_add_u32 v6, v4, 10, s27
    s_mov_b64 exec, 0xffff
    global_load_dword v14, v6, s[4:5]
    s_mov_b64 exec, -1
    ds_read_b64 a[64:65], v9 offset:1024
    ds_read_b64 a[66:67], v9 offset:1032
    ds_read_b64 a[68:69], v9 offset:1088
    ds_read_b64 a[70:71], v9 offset:1096
    ds_read_b64 a[72:73], v9 offset:1152
    ds_read_b64 a[74:75], v9 offset:1160
    ds_read_b64 a[76:77], v9 offset:1216
    ds_read_b64 a[78:79], v9 offset:1224
    s_lshl_b32 s37, s33, 13
    s_add_u32 s35, s35, s37
    v_lshl_add_u32 v32, v4, 6, s35
    v_lshl_add_u32 v32, v5, 11, v32
    v_cndmask_b32 v31, v32, 2.0, s[38:39]
    s_lshl1_add_u32 s35, s56, 1
    v_mul_u32_u24 v26, s35, v0
    s_and_b32 s35, s56, s33
    ds_read_b64 a[80:81], v9 offset:1280
    ds_read_b64 a[82:83], v9 offset:1288
    ds_read_b64 a[84:85], v9 offset:1344
    ds_read_b64 a[86:87], v9 offset:1352
    ds_read_b64 a[88:89], v9 offset:1408
    ds_read_b64 a[90:91], v9 offset:1416
    ds_read_b64 a[92:93], v9 offset:1472
    ds_read_b64 a[94:95], v9 offset:1480
    v_subrev_u32 v26, s35, v26
    v_and_b32 v26, 3, v26
    v_mul_u32_u24 v37, 1088, v26
    s_sub_u32 s35, s56, s35
    v_subrev_u32 v27, s35, v15
    v_ashrrev_i32 v27, 2, v27
    v_and_b32 v26, -16, v27
    v_bfe_u32 v40, v27, 2, 2
    ds_read_b64 a[96:97], v9 offset:1536
    ds_read_b64 a[98:99], v9 offset:1544
    ds_read_b64 a[100:101], v9 offset:1600
    ds_read_b64 a[102:103], v9 offset:1608
    ds_read_b64 a[104:105], v9 offset:1664
    ds_read_b64 a[106:107], v9 offset:1672
    ds_read_b64 a[108:109], v9 offset:1728
    ds_read_b64 a[110:111], v9 offset:1736
    v_and_b32 v27, 3, v27
    v_lshl_add_u32 v26, v27, 2, v26
    v_add_lshl_u32 v26, v26, v40, 4
    v_add3_u32 v37, v37, v26, 16
    s_mul_i32 s35, s26, 4352
    v_add_u32 v36, s35, v3
    s_add_u32 s35, s35, 30580
    v_cmp_eq_u32 s[38:39], 63, v2
    ds_read_b64 a[112:113], v9 offset:1792
    ds_read_b64 a[114:115], v9 offset:1800
    ds_read_b64 a[116:117], v9 offset:1856
    ds_read_b64 a[118:119], v9 offset:1864
    ds_read_b64 a[120:121], v9 offset:1920
    ds_read_b64 a[122:123], v9 offset:1928
    ds_read_b64 a[124:125], v9 offset:1984
    ds_read_b64 a[126:127], v9 offset:1992
    v_mov_b32 v26, s35
    v_lshlrev_b32 v40, 2, v2
    v_cndmask_b32 v26, 0, v26, s[38:39]
    v_add_u32 v40, v40, v26
    v_and_b32 v26, 127, v15
    v_lshrrev_b32 v27, 7, v15
    s_lshl_b32 s35, s33, 13
    s_add_u32 s35, s35, 6291456
    buffer_load_dwordx2 v[16:17], v24, s[44:47], 0 offen
    v_lshl_add_u32 v33, v26, 6, s35
    v_lshl_add_u32 v33, v27, 4, v33
    s_mul_i32 s35, s26, 1280
    v_lshl_add_u32 v38, v2, 2, s35
    v_and_b32_e64 v26, 3, v0
    v_mul_u32_u24 v26, 287, v26
    s_mov_b32 s35, 48256
    v_add3_u32 v39, v26, v0, s35
    v_pk_mov_b32 v[46:47], 0, 0
    v_pk_mov_b32 v[48:49], 0, 0
    v_pk_mov_b32 v[84:85], 0, 0
    v_pk_mov_b32 v[50:51], 0, 0
    v_pk_mov_b32 v[52:53], 0, 0
    v_pk_mov_b32 v[86:87], 0, 0
    v_pk_mov_b32 v[76:77], 0, 0
    v_pk_mov_b32 v[78:79], 0, 0
    buffer_load_dwordx2 v[18:19], v24, s[44:47], s48 offen
    s_waitcnt vmcnt(4)
    v_mov_b32_dpp v13, v65 wave_ror:1 row_mask:0xf bank_mask:0xf
    v_mov_b32_dpp v12, v65 wave_shr:1 row_mask:0xf bank_mask:0xf
    s_nop 0
    v_mov_b32_dpp v13, v69 wave_shr:1 row_mask:0xf bank_mask:0xf
    v_alignbit_b32 v55, v63, v62, s36
    v_alignbit_b32 v56, v64, v63, s36
    v_alignbit_b32 v57, v65, v64, s36
    v_alignbit_b32 v54, v62, v12, s36
    ds_write_b128 v8, v[54:57] offset:2112
    v_alignbit_b32 v59, v67, v66, s36
    v_alignbit_b32 v60, v68, v67, s36
    v_alignbit_b32 v61, v69, v68, s36
    v_alignbit_b32 v58, v66, v13, s36
    ds_write_b128 v8, v[58:61] offset:3136
    s_cmp_eq_u32 s33, 1
    s_cbranch_scc1 L_gated__noshift_10
    v_mov_b32_dpp v65, v58 wave_rol:1 row_mask:0xf bank_mask:0xf
    v_pk_mov_b32 v[62:63], v[54:55], v[56:57] op_sel:[1,0]
    v_mov_b32 v64, v57
    v_pk_mov_b32 v[66:67], v[58:59], v[60:61] op_sel:[1,0]
    v_mov_b32 v68, v61
    v_mov_b32_dpp v65, v54 wave_shl:1 row_mask:0xf bank_mask:0xf
    v_mov_b32_dpp v69, v58 wave_shl:1 row_mask:0xf bank_mask:0xf
L_gated__noshift_10:
    ds_write_b32 v8, v54 offset:6332
    ds_write_b128 v8, v[62:65] offset:6336
    ds_write_b128 v8, v[66:69] offset:7360
    s_cmp_lg_u32 s26, 0
    s_cbranch_scc1 L_gated__nopoll0_11
    s_mov_b64 exec, 0xffff
    global_load_dword v1, v7, s[22:23] sc1
    s_mov_b64 exec, -1
L_gated__nopoll0_11:
    ds_read_b64 a[128:129], v9 offset:2048
    ds_read_b64 a[130:131], v9 offset:2056
    ds_read_b64 a[132:133], v9 offset:2112
    ds_read_b64 a[134:135], v9 offset:2120
    ds_read_b64 a[136:137], v9 offset:2176
    ds_read_b64 a[138:139], v9 offset:2184
    ds_read_b64 a[140:141], v9 offset:2240
    ds_read_b64 a[142:143], v9 offset:2248
    v_pk_mov_b32 v[88:89], 0, 0
    v_pk_mov_b32 v[80:81], 0, 0
    v_pk_mov_b32 v[82:83], 0, 0
    v_pk_mov_b32 v[90:91], 0, 0
    s_mul_i32 s35, s26, 5152
    v_mul_u32_u24 v41, 1280, v5
    v_lshl_add_u32 v41, v4, 4, v41
    v_add_u32 v42, s35, v41
    ds_read_b64 a[144:145], v9 offset:2304
    ds_read_b64 a[146:147], v9 offset:2312
    ds_read_b64 a[148:149], v9 offset:2368
    ds_read_b64 a[150:151], v9 offset:2376
    ds_read_b64 a[152:153], v9 offset:2432
    ds_read_b64 a[154:155], v9 offset:2440
    ds_read_b64 a[156:157], v9 offset:2496
    ds_read_b64 a[158:159], v9 offset:2504
    ds_write_b128 v42, v[46:49] offset:10240
    v_lshrrev_b32 v72, 2, v4
    v_and_b32 v43, 3, v0
    v_lshl_add_u32 v43, v43, 2, v72
    s_mul_i32 s35, s33, 0x02020000
    s_add_u32 s57, s35, 0x01000c0c
    s_lshl_b32 s37, s56, 31
    s_xor_b32 s37, s37, 0x3d800000
    ds_read_b64 a[160:161], v9 offset:2560
    ds_read_b64 a[162:163], v9 offset:2568
    ds_read_b64 a[164:165], v9 offset:2624
    ds_read_b64 a[166:167], v9 offset:2632
    ds_read_b64 a[168:169], v9 offset:2688
    ds_read_b64 a[170:171], v9 offset:2696
    ds_read_b64 a[172:173], v9 offset:2752
    ds_read_b64 a[174:175], v9 offset:2760
    v_cvt_f32_u32 v73, v5
    v_cvt_f32_u32 v71, v43
    v_add_u32 v43, s56, v43
    v_mul_f32 v71, s37, v71
    v_mul_f32 v72, 4.0, v73
    v_mul_f32 v44, v71, v72
    v_add_f32 v97, v71, v44
    v_add_f32 v98, v71, v97
    ds_read_b64 a[176:177], v9 offset:2816
    ds_read_b64 a[178:179], v9 offset:2824
    ds_read_b64 a[180:181], v9 offset:2880
    ds_read_b64 a[182:183], v9 offset:2888
    ds_read_b64 a[184:185], v9 offset:2944
    ds_read_b64 a[186:187], v9 offset:2952
    ds_read_b64 a[188:189], v9 offset:3008
    ds_read_b64 a[190:191], v9 offset:3016
    v_add_f32 v99, v71, v98
    v_cos_f32 v92, v44
    v_sin_f32 v96, v44
    v_cos_f32 v93, v97
    v_sin_f32 v97, v97
    s_cmp_lg_u32 s26, 0
    s_cbranch_scc1 L_gated__nopoll_12
    s_mov_b64 exec, 0xffff
    s_mov_b32 s28, 0
    s_mov_b32 s29, 16
    s_waitcnt vmcnt(0)
L_gated__poll_13:
    v_cmp_gt_u32 vcc, s29, v1
    s_nop 1
    s_and_b64 exec, exec, vcc
    s_cbranch_scc0 L_gated__done_14
    global_load_dword v1, v7, s[22:23] sc1
    s_add_u32 s28, s28, 1
    s_cmp_lt_u32 s28, 0x100000
    s_cselect_b32 s29, 16, 0
    s_waitcnt vmcnt(0)
    s_branch L_gated__poll_13
L_gated__done_14:
    s_mov_b64 exec, -1
L_gated__nopoll_12:
    s_barrier
    global_load_dwordx4 v[10:13], v28, s[22:23] offset:-4096 sc1
    global_load_dwordx4 v[54:57], v28, s[22:23] offset:0 sc1
    s_mov_b64 exec, 0xffff
    global_load_dwordx4 v[84:87], v34, s[22:23] sc1
    global_load_dwordx4 v[88:91], v35, s[22:23] sc1
    s_mov_b64 exec, -1
    buffer_load_dwordx4 v[108:111], v31, s[40:43], 0 offen sc1
    buffer_load_dwordx4 v[112:115], v32, s[40:43], 0 offen offset:1024 sc1
    global_load_dwordx4 v[66:69], v33, s[22:23] sc1
    ds_read_b64 a[192:193], v9 offset:3072
    ds_read_b64 a[194:195], v9 offset:3080
    ds_read_b64 a[196:197], v9 offset:3136
    ds_read_b64 a[198:199], v9 offset:3144
    ds_read_b64 a[200:201], v9 offset:3200
    ds_read_b64 a[202:203], v9 offset:3208
    ds_read_b64 a[204:205], v9 offset:3264
    ds_read_b64 a[206:207], v9 offset:3272
    v_cos_f32 v94, v98
    v_sin_f32 v98, v98
    v_cos_f32 v95, v99
    v_sin_f32 v99, v99
    ds_read_b64 a[208:209], v9 offset:3328
    ds_read_b64 a[210:211], v9 offset:3336
    ds_read_b64 a[212:213], v9 offset:3392
    ds_read_b64 a[214:215], v9 offset:3400
    ds_read_b64 a[216:217], v9 offset:3456
    ds_read_b64 a[218:219], v9 offset:3464
    ds_read_b64 a[220:221], v9 offset:3520
    ds_read_b64 a[222:223], v9 offset:3528
    v_cvt_f32_u32 v71, v43
    s_mul_i32 s35, s33, 0x41000000
    v_cvt_pk_bf16_f32 v100, v92, v93
    v_cvt_pk_bf16_f32 v102, v96, v97
    v_cvt_pk_bf16_f32 v101, v94, v95
    v_cvt_pk_bf16_f32 v103, v98, v99
    v_mul_f32 v71, s37, v71
    v_fma_f32 v73, 2.0, v73, s35
    ds_read_b64 a[224:225], v9 offset:3584
    ds_read_b64 a[226:227], v9 offset:3592
    ds_read_b64 a[228:229], v9 offset:3648
    ds_read_b64 a[230:231], v9 offset:3656
    ds_read_b64 a[232:233], v9 offset:3712
    ds_read_b64 a[234:235], v9 offset:3720
    ds_read_b64 a[236:237], v9 offset:3776
    ds_read_b64 a[238:239], v9 offset:3784
    v_mul_f32 v44, v71, v73
    v_add_f32 v97, v71, v44
    v_cos_f32 v92, v44
    v_sin_f32 v96, v44
    v_cos_f32 v93, v97
    ds_read_b64 a[240:241], v9 offset:3840
    ds_read_b64 a[242:243], v9 offset:3848
    ds_read_b64 a[244:245], v9 offset:3904
    ds_read_b64 a[246:247], v9 offset:3912
    ds_read_b64 a[248:249], v9 offset:3968
    ds_read_b64 a[250:251], v9 offset:3976
    ds_read_b64 a[252:253], v9 offset:4032
    ds_read_b64 a[254:255], v9 offset:4040
    v_sin_f32 v97, v97
    v_mul_f32 v71, 0x3d800000, v71
    v_lshlrev_b32 v43, 31, v43
    v_cvt_pk_bf16_f32 v104, v92, v96
    v_cvt_pk_bf16_f32 v106, -v96, v92
    v_cvt_pk_bf16_f32 v105, v93, v97
    v_cvt_pk_bf16_f32 v107, -v97, v93
    v_mul_f32 v44, v71, v72
    v_xor_b32 v74, 1.0, v43
    v_add_f32 v97, v71, v44
    v_add_f32 v98, v71, v97
    v_add_f32 v99, v71, v98
    v_cos_f32 v92, v44
    v_sin_f32 v96, v44
    v_cos_f32 v93, v97
    v_sin_f32 v97, v97
    v_cos_f32 v94, v98
    v_sin_f32 v98, v98
    v_cos_f32 v95, v99
    v_sin_f32 v99, v99
    s_branch L_gated__page_15
.p2align 12
.fill 1, 4, 0xbf800000
L_gated__page_15:
    s_waitcnt vmcnt(6)
    ds_write_b128 v30, v[10:13] offset:10496
    s_waitcnt vmcnt(5)
    ds_write_b128 v30, v[54:57] offset:10752
    s_waitcnt lgkmcnt(0)
    s_barrier
    ds_read_b128 v[2:5], v42 offset:10496
    ds_read_b128 v[6:9], v42 offset:10480
    ds_read_b128 v[10:13], v42 offset:10464
    ds_read_b128 v[70:73], v42 offset:10448
    ds_read_b128 v[116:119], v42 offset:10432
    ds_read_b128 v[120:123], v42 offset:10416
    s_waitcnt lgkmcnt(5)
    v_mfma_f32_16x16x32_bf16 v[240:243], a[0:3], v[2:5], 0
    s_waitcnt lgkmcnt(4)
    ds_read_b128 v[124:127], v42 offset:10400
    v_mfma_f32_16x16x32_bf16 v[240:243], a[4:7], v[6:9], v[240:243]
    s_waitcnt lgkmcnt(4)
    ds_read_b128 v[128:131], v42 offset:10384
    v_mfma_f32_16x16x32_bf16 v[240:243], a[8:11], v[10:13], v[240:243]
    s_waitcnt vmcnt(4) lgkmcnt(4)
    ds_read_b128 v[132:135], v42 offset:10368
    v_perm_b32 v84, v84, v84, s57
    v_mfma_f32_16x16x32_bf16 v[240:243], a[12:15], v[70:73], v[240:243]
    s_waitcnt lgkmcnt(4)
    ds_read_b128 v[136:139], v42 offset:10352
    v_perm_b32 v85, v85, v85, s57
    v_mfma_f32_16x16x32_bf16 v[240:243], a[16:19], v[116:119], v[240:243]
    s_waitcnt lgkmcnt(4)
    ds_read_b128 v[140:143], v42 offset:10336
    v_perm_b32 v86, v86, v86, s57
    v_mfma_f32_16x16x32_bf16 v[240:243], a[20:23], v[120:123], v[240:243]
    s_waitcnt lgkmcnt(4)
    ds_read_b128 v[144:147], v42 offset:10320
    v_perm_b32 v87, v87, v87, s57
    v_mfma_f32_16x16x32_bf16 v[240:243], a[24:27], v[124:127], v[240:243]
    s_waitcnt vmcnt(3) lgkmcnt(4)
    ds_read_b128 v[148:151], v42 offset:10304
    v_perm_b32 v88, v88, v88, s57
    v_mfma_f32_16x16x32_bf16 v[240:243], a[28:31], v[128:131], v[240:243]
    s_waitcnt lgkmcnt(4)
    ds_read_b128 v[152:155], v42 offset:10288
    v_perm_b32 v89, v89, v89, s57
    v_mfma_f32_16x16x32_bf16 v[240:243], a[32:35], v[132:135], v[240:243]
    s_waitcnt lgkmcnt(4)
    ds_read_b128 v[156:159], v42 offset:10272
    global_load_dwordx4 v[58:61], v29, s[22:23] offset:-4096 sc1
    v_mfma_f32_16x16x32_bf16 v[240:243], a[36:39], v[136:139], v[240:243]
    s_waitcnt lgkmcnt(4)
    ds_read_b128 v[160:163], v42 offset:10256
    v_perm_b32 v90, v90, v90, s57
    v_mfma_f32_16x16x32_bf16 v[240:243], a[40:43], v[140:143], v[240:243]
    s_waitcnt lgkmcnt(4)
    ds_read_b128 v[164:167], v42 offset:10752
    global_load_dwordx4 v[62:65], v29, s[22:23] offset:0 sc1
    v_mfma_f32_16x16x32_bf16 v[240:243], a[44:47], v[144:147], v[240:243]
    s_waitcnt lgkmcnt(4)
    ds_read_b128 v[168:171], v42 offset:10736
    v_perm_b32 v91, v91, v91, s57
    v_mfma_f32_16x16x32_bf16 v[240:243], a[48:51], v[148:151], v[240:243]
    s_waitcnt lgkmcnt(4)
    ds_read_b128 v[172:175], v42 offset:10720
    v_fma_f32 v46, v88, v74, v84
    v_mfma_f32_16x16x32_bf16 v[240:243], a[52:55], v[152:155], v[240:243]
    s_waitcnt lgkmcnt(4)
    ds_read_b128 v[176:179], v42 offset:10704
    v_fma_f32 v50, v89, v74, v85
    v_mfma_f32_16x16x32_bf16 v[240:243], a[56:59], v[156:159], v[240:243]
    s_waitcnt lgkmcnt(4)
    ds_read_b128 v[180:183], v42 offset:10688
    v_fma_f32 v76, v90, v74, v86
    v_mfma_f32_16x16x32_bf16 v[240:243], a[60:63], v[160:163], v[240:243]
    ds_read_b128 v[184:187], v42 offset:10672
    v_fma_f32 v80, v91, v74, v87
    v_mfma_f32_16x16x32_bf16 v[244:247], a[64:67], v[2:5], 0
    ds_read_b128 v[188:191], v42 offset:10656
    v_mfma_f32_16x16x32_bf16 v[244:247], a[68:71], v[6:9], v[244:247]
    ds_read_b128 v[192:195], v42 offset:10640
    v_mfma_f32_16x16x32_bf16 v[244:247], a[72:75], v[10:13], v[244:247]
    s_waitcnt vmcnt(3)
    ds_read_b128 v[196:199], v42 offset:10624
    v_swap_b32 v109, v112
    v_mfma_f32_16x16x32_bf16 v[244:247], a[76:79], v[70:73], v[244:247]
    ds_read_b128 v[200:203], v42 offset:10608
    v_swap_b32 v111, v114
    v_mfma_f32_16x16x32_bf16 v[244:247], a[80:83], v[116:119], v[244:247]
    ds_read_b128 v[204:207], v42 offset:10592
    buffer_load_dwordx2 v[20:21], v24, s[44:47], s49 offen
    v_mfma_f32_16x16x16_bf16 v[224:227], v[108:109], v[106:107], 0
    ds_read_b128 v[208:211], v42 offset:10576
    v_mfma_f32_16x16x16_bf16 v[46:49], v[108:109], v[104:105], v[46:49]
    ds_read_b128 v[212:215], v42 offset:10560
    v_mfma_f32_16x16x16_bf16 v[228:231], v[112:113], v[106:107], 0
    ds_read_b128 v[216:219], v42 offset:10544
    v_mfma_f32_16x16x16_bf16 v[50:53], v[112:113], v[104:105], v[50:53]
    ds_read_b128 v[220:223], v42 offset:10528
    v_mfma_f32_16x16x16_bf16 v[232:235], v[110:111], v[106:107], 0
    ds_read_b128 v[54:57], v42 offset:10512
    v_mfma_f32_16x16x16_bf16 v[76:79], v[110:111], v[104:105], v[76:79]
    ds_write_b32 v38, v240 offset:48256
    v_mfma_f32_16x16x16_bf16 v[236:239], v[114:115], v[106:107], 0
    ds_write_b32 v38, v241 offset:48544
    v_mfma_f32_16x16x16_bf16 v[80:83], v[114:115], v[104:105], v[80:83]
    ds_write_b32 v38, v242 offset:48832
    v_mfma_f32_16x16x32_bf16 v[244:247], a[84:87], v[120:123], v[244:247]
    ds_write_b32 v38, v243 offset:49120
    v_pk_mul_f32 v[248:249], v[224:225], v[96:97]
    v_pk_mul_f32 v[224:225], v[224:225], v[92:93]
    v_pk_mul_f32 v[250:251], v[226:227], v[98:99]
    v_pk_mul_f32 v[226:227], v[226:227], v[94:95]
    v_pk_fma_f32 v[224:225], v[46:47], v[96:97], v[224:225] neg_lo:[1,0,0] neg_hi:[1,0,0]
    v_pk_fma_f32 v[46:47], v[46:47], v[92:93], v[248:249]
    v_pk_fma_f32 v[226:227], v[48:49], v[98:99], v[226:227] neg_lo:[1,0,0] neg_hi:[1,0,0]
    v_pk_fma_f32 v[48:49], v[48:49], v[94:95], v[250:251]
    v_pk_mul_f32 v[248:249], v[228:229], v[96:97]
    v_pk_mul_f32 v[228:229], v[228:229], v[92:93]
    v_pk_mul_f32 v[250:251], v[230:231], v[98:99]
    v_pk_mul_f32 v[230:231], v[230:231], v[94:95]
    v_pk_fma_f32 v[228:229], v[50:51], v[96:97], v[228:229] neg_lo:[1,0,0] neg_hi:[1,0,0]
    v_pk_fma_f32 v[50:51], v[50:51], v[92:93], v[248:249]
    v_pk_fma_f32 v[230:231], v[52:53], v[98:99], v[230:231] neg_lo:[1,0,0] neg_hi:[1,0,0]
    v_pk_fma_f32 v[52:53], v[52:53], v[94:95], v[250:251]
    v_pk_mul_f32 v[248:249], v[232:233], v[96:97]
    v_pk_mul_f32 v[232:233], v[232:233], v[92:93]
    v_pk_mul_f32 v[250:251], v[234:235], v[98:99]
    v_pk_mul_f32 v[234:235], v[234:235], v[94:95]
    v_pk_fma_f32 v[232:233], v[76:77], v[96:97], v[232:233] neg_lo:[1,0,0] neg_hi:[1,0,0]
    v_pk_fma_f32 v[76:77], v[76:77], v[92:93], v[248:249]
    v_pk_fma_f32 v[234:235], v[78:79], v[98:99], v[234:235] neg_lo:[1,0,0] neg_hi:[1,0,0]
    v_pk_fma_f32 v[78:79], v[78:79], v[94:95], v[250:251]
    v_pk_mul_f32 v[248:249], v[236:237], v[96:97]
    v_pk_mul_f32 v[236:237], v[236:237], v[92:93]
    v_pk_mul_f32 v[250:251], v[238:239], v[98:99]
    v_pk_mul_f32 v[238:239], v[238:239], v[94:95]
    v_pk_fma_f32 v[236:237], v[80:81], v[96:97], v[236:237] neg_lo:[1,0,0] neg_hi:[1,0,0]
    v_pk_fma_f32 v[80:81], v[80:81], v[92:93], v[248:249]
    v_pk_fma_f32 v[238:239], v[82:83], v[98:99], v[238:239] neg_lo:[1,0,0] neg_hi:[1,0,0]
    v_pk_fma_f32 v[82:83], v[82:83], v[94:95], v[250:251]
    v_mfma_f32_16x16x32_bf16 v[244:247], a[88:91], v[124:127], v[244:247]
    v_cvt_pk_bf16_f32 v110, v224, v225
    v_cvt_pk_bf16_f32 v111, v226, v227
    v_mfma_f32_16x16x32_bf16 v[244:247], a[92:95], v[128:131], v[244:247]
    v_cvt_pk_bf16_f32 v108, v46, v47
    v_cvt_pk_bf16_f32 v109, v48, v49
    v_mfma_f32_16x16x32_bf16 v[244:247], a[96:99], v[132:135], v[244:247]
    v_cvt_pk_bf16_f32 v114, v228, v229
    v_cvt_pk_bf16_f32 v115, v230, v231
    v_mfma_f32_16x16x32_bf16 v[46:49], v[100:103], v[108:111], 0
    v_cvt_pk_bf16_f32 v112, v50, v51
    v_cvt_pk_bf16_f32 v113, v52, v53
    v_mfma_f32_16x16x32_bf16 v[244:247], a[100:103], v[136:139], v[244:247]
    v_cvt_pk_bf16_f32 v86, v232, v233
    v_cvt_pk_bf16_f32 v87, v234, v235
    v_mfma_f32_16x16x32_bf16 v[244:247], a[104:107], v[140:143], v[244:247]
    v_cvt_pk_bf16_f32 v84, v76, v77
    v_cvt_pk_bf16_f32 v85, v78, v79
    v_mfma_f32_16x16x32_bf16 v[50:53], v[100:103], v[112:115], 0
    ds_write_b128 v36, v[46:49] offset:30848
    v_mfma_f32_16x16x32_bf16 v[244:247], a[108:111], v[144:147], v[244:247]
    v_cvt_pk_bf16_f32 v90, v236, v237
    v_cvt_pk_bf16_f32 v91, v238, v239
    v_mfma_f32_16x16x32_bf16 v[244:247], a[112:115], v[148:151], v[244:247]
    v_cvt_pk_bf16_f32 v88, v80, v81
    v_cvt_pk_bf16_f32 v89, v82, v83
    v_mfma_f32_16x16x32_bf16 v[76:79], v[100:103], v[84:87], 0
    ds_write_b128 v36, v[50:53] offset:31936
    v_mfma_f32_16x16x32_bf16 v[244:247], a[116:119], v[152:155], v[244:247]
    v_lshlrev_b32 v104, 16, v16
    v_and_b32 v105, s34, v16
    v_mfma_f32_16x16x32_bf16 v[244:247], a[120:123], v[156:159], v[244:247]
    v_lshlrev_b32 v106, 16, v17
    v_and_b32 v107, s34, v17
    v_mfma_f32_16x16x32_bf16 v[80:83], v[100:103], v[88:91], 0
    ds_write_b128 v36, v[76:79] offset:33024
    v_mfma_f32_16x16x32_bf16 v[244:247], a[124:127], v[160:163], v[244:247]
    s_waitcnt vmcnt(3) lgkmcnt(15)
    v_mul_f32 v104, v66, v104
    v_mul_f32 v105, v66, v105
    v_mfma_f32_16x16x32_bf16 v[244:247], a[0:3], v[164:167], v[244:247]
    buffer_load_dwordx2 v[22:23], v24, s[44:47], s50 offen
    v_mul_f32 v106, v66, v106
    v_mfma_f32_16x16x32_bf16 v[244:247], a[4:7], v[168:171], v[244:247]
    ds_write_b128 v36, v[80:83] offset:34112
    v_mfma_f32_16x16x32_bf16 v[244:247], a[8:11], v[172:175], v[244:247]
    v_mul_f32 v107, v66, v107
    v_mfma_f32_16x16x32_bf16 v[244:247], a[12:15], v[176:179], v[244:247]
    v_mfma_f32_16x16x32_bf16 v[244:247], a[16:19], v[180:183], v[244:247]
    ds_write2_b32 v40, v49, v46 offset0:0 offset1:1
    v_mfma_f32_16x16x32_bf16 v[244:247], a[20:23], v[184:187], v[244:247]
    ds_write2_b32 v40, v47, v48 offset0:2 offset1:3
    v_mfma_f32_16x16x32_bf16 v[244:247], a[24:27], v[188:191], v[244:247]
    v_mfma_f32_16x16x32_bf16 v[244:247], a[28:31], v[192:195], v[244:247]
    s_waitcnt lgkmcnt(15)
    v_mfma_f32_16x16x32_bf16 v[244:247], a[32:35], v[196:199], v[244:247]
    v_mfma_f32_16x16x32_bf16 v[244:247], a[36:39], v[200:203], v[244:247]
    s_waitcnt lgkmcnt(0)
    v_mfma_f32_16x16x32_bf16 v[244:247], a[40:43], v[204:207], v[244:247]
    s_barrier
    ds_read2st64_b32 v[248:249], v39 offset0:0 offset1:5
    v_mfma_f32_16x16x32_bf16 v[244:247], a[44:47], v[208:211], v[244:247]
    ds_read2st64_b32 v[250:251], v39 offset0:10 offset1:15
    v_mfma_f32_16x16x32_bf16 v[244:247], a[48:51], v[212:215], v[244:247]
    ds_read_b128 v[46:49], v37 offset:30832
    v_mfma_f32_16x16x32_bf16 v[244:247], a[52:55], v[216:219], v[244:247]
    ds_read_b128 v[50:53], v37 offset:35184
    v_mfma_f32_16x16x32_bf16 v[244:247], a[56:59], v[220:223], v[244:247]
    ds_read_b128 v[76:79], v37 offset:39536
    v_mfma_f32_16x16x32_bf16 v[244:247], a[60:63], v[54:57], v[244:247]
    ds_read_b128 v[80:83], v37 offset:43888
    v_mfma_f32_16x16x32_bf16 v[240:243], a[128:131], v[2:5], 0
    s_waitcnt vmcnt(3)
    ds_write_b128 v30, v[58:61] offset:11008
    v_mfma_f32_16x16x32_bf16 v[240:243], a[64:67], v[164:167], v[240:243]
    s_waitcnt lgkmcnt(6)
    v_mul_f32 v248, v104, v248
    v_mul_f32 v249, v105, v249
    v_mfma_f32_16x16x32_bf16 v[240:243], a[132:135], v[6:9], v[240:243]
    s_waitcnt lgkmcnt(5)
    v_mul_f32 v250, v106, v250
    v_mul_f32 v251, v107, v251
    v_mfma_f32_16x16x32_bf16 v[240:243], a[68:71], v[168:171], v[240:243]
    s_waitcnt vmcnt(2)
    ds_write_b128 v30, v[62:65] offset:11264
    v_mfma_f32_16x16x32_bf16 v[240:243], a[136:139], v[10:13], v[240:243]
    s_waitcnt lgkmcnt(5)
    v_sub_f32 v66, 1.0, v66
    v_fmac_f32 v248, v66, v46
    v_mfma_f32_16x16x32_bf16 v[240:243], a[72:75], v[172:175], v[240:243]
    s_waitcnt lgkmcnt(3)
    v_fmac_f32 v249, v66, v50
    v_fmac_f32 v250, v66, v76
    v_mfma_f32_16x16x32_bf16 v[240:243], a[140:143], v[70:73], v[240:243]
    s_waitcnt lgkmcnt(2)
    ds_write_b32 v38, v244 offset:53376
    v_fmac_f32 v251, v66, v80
    v_mfma_f32_16x16x32_bf16 v[240:243], a[76:79], v[176:179], v[240:243]
    ds_write_b32 v38, v245 offset:53664
    v_cvt_pk_bf16_f32 v16, v248, v249
    v_mfma_f32_16x16x32_bf16 v[240:243], a[144:147], v[116:119], v[240:243]
    s_waitcnt lgkmcnt(2)
    ds_write_b32 v38, v246 offset:53952
    v_cvt_pk_bf16_f32 v17, v250, v251
    v_mfma_f32_16x16x32_bf16 v[240:243], a[80:83], v[180:183], v[240:243]
    s_barrier
    ds_write_b32 v38, v247 offset:54240
    buffer_store_dwordx2 v[16:17], v24, s[52:55], 0 offen
    v_mfma_f32_16x16x32_bf16 v[240:243], a[148:151], v[120:123], v[240:243]
    v_lshlrev_b32 v104, 16, v18
    v_and_b32 v105, s34, v18
    v_mfma_f32_16x16x32_bf16 v[240:243], a[84:87], v[184:187], v[240:243]
    v_lshlrev_b32 v106, 16, v19
    v_and_b32 v107, s34, v19
    v_mfma_f32_16x16x32_bf16 v[240:243], a[152:155], v[124:127], v[240:243]
    v_mul_f32 v104, v67, v104
    v_mul_f32 v105, v67, v105
    v_mfma_f32_16x16x32_bf16 v[240:243], a[88:91], v[188:191], v[240:243]
    s_waitcnt lgkmcnt(0)
    v_mul_f32 v106, v67, v106
    v_mul_f32 v107, v67, v107
    v_mfma_f32_16x16x32_bf16 v[240:243], a[156:159], v[128:131], v[240:243]
    s_barrier
    ds_read2st64_b32 v[248:249], v39 offset0:20 offset1:25
    v_fma_f32 v47, -v67, v47, v47
    v_mfma_f32_16x16x32_bf16 v[240:243], a[92:95], v[192:195], v[240:243]
    ds_read2st64_b32 v[250:251], v39 offset0:30 offset1:35
    v_fma_f32 v51, -v67, v51, v51
    v_mfma_f32_16x16x32_bf16 v[240:243], a[160:163], v[132:135], v[240:243]
    ds_read_b128 v[58:61], v42 offset:11008
    v_fma_f32 v77, -v67, v77, v77
    v_mfma_f32_16x16x32_bf16 v[240:243], a[96:99], v[196:199], v[240:243]
    ds_read_b128 v[62:65], v42 offset:10992
    v_fma_f32 v81, -v67, v81, v81
    v_mfma_f32_16x16x32_bf16 v[240:243], a[164:167], v[136:139], v[240:243]
    ds_read_b128 v[108:111], v42 offset:10976
    v_mfma_f32_16x16x32_bf16 v[240:243], a[100:103], v[200:203], v[240:243]
    ds_read_b128 v[112:115], v42 offset:10960
    v_mfma_f32_16x16x32_bf16 v[240:243], a[168:171], v[140:143], v[240:243]
    ds_read_b128 v[224:227], v42 offset:10944
    v_mfma_f32_16x16x32_bf16 v[240:243], a[104:107], v[204:207], v[240:243]
    s_waitcnt lgkmcnt(6)
    ds_read_b128 v[228:231], v42 offset:10928
    v_fma_f32 v248, v104, v248, v47
    v_mfma_f32_16x16x32_bf16 v[240:243], a[172:175], v[144:147], v[240:243]
    ds_read_b128 v[232:235], v42 offset:10912
    v_fma_f32 v249, v105, v249, v51
    v_mfma_f32_16x16x32_bf16 v[240:243], a[108:111], v[208:211], v[240:243]
    s_waitcnt lgkmcnt(7)
    ds_read_b128 v[236:239], v42 offset:10896
    v_fma_f32 v250, v106, v250, v77
    v_mfma_f32_16x16x32_bf16 v[240:243], a[176:179], v[148:151], v[240:243]
    v_fma_f32 v251, v107, v251, v81
    v_cvt_pk_bf16_f32 v18, v248, v249
    v_mfma_f32_16x16x32_bf16 v[240:243], a[112:115], v[212:215], v[240:243]
    s_waitcnt lgkmcnt(7)
    v_cvt_pk_bf16_f32 v19, v250, v251
    v_mfma_f32_16x16x32_bf16 v[240:243], a[0:3], v[58:61], v[240:243]
    s_waitcnt lgkmcnt(6)
    ds_read_b128 v[58:61], v42 offset:10880
    buffer_store_dwordx2 v[18:19], v24, s[52:55], s48 offen
    v_mfma_f32_16x16x32_bf16 v[240:243], a[4:7], v[62:65], v[240:243]
    s_waitcnt vmcnt(3) lgkmcnt(6)
    ds_read_b128 v[62:65], v42 offset:10864
    v_lshlrev_b32 v104, 16, v20
    v_mfma_f32_16x16x32_bf16 v[240:243], a[8:11], v[108:111], v[240:243]
    ds_read_b128 v[108:111], v42 offset:10848
    v_and_b32 v105, s34, v20
    v_mfma_f32_16x16x32_bf16 v[240:243], a[180:183], v[152:155], v[240:243]
    s_waitcnt lgkmcnt(7)
    v_lshlrev_b32 v106, 16, v21
    v_and_b32 v107, s34, v21
    v_mfma_f32_16x16x32_bf16 v[240:243], a[12:15], v[112:115], v[240:243]
    s_waitcnt lgkmcnt(6)
    ds_read_b128 v[112:115], v42 offset:10832
    v_mul_f32 v104, v68, v104
    v_mfma_f32_16x16x32_bf16 v[240:243], a[16:19], v[224:227], v[240:243]
    s_waitcnt lgkmcnt(6)
    ds_read_b128 v[224:227], v42 offset:10816
    v_mul_f32 v105, v68, v105
    v_mfma_f32_16x16x32_bf16 v[240:243], a[20:23], v[228:231], v[240:243]
    ds_read_b128 v[228:231], v42 offset:10800
    v_mul_f32 v106, v68, v106
    v_mfma_f32_16x16x32_bf16 v[240:243], a[116:119], v[216:219], v[240:243]
    s_waitcnt lgkmcnt(7)
    v_mul_f32 v107, v68, v107
    v_fma_f32 v48, -v68, v48, v48
    v_mfma_f32_16x16x32_bf16 v[240:243], a[24:27], v[232:235], v[240:243]
    s_waitcnt lgkmcnt(6)
    ds_read_b128 v[232:235], v42 offset:10784
    v_fma_f32 v52, -v68, v52, v52
    v_mfma_f32_16x16x32_bf16 v[240:243], a[28:31], v[236:239], v[240:243]
    ds_read_b128 v[236:239], v42 offset:10768
    v_fma_f32 v78, -v68, v78, v78
    v_mfma_f32_16x16x32_bf16 v[240:243], a[184:187], v[156:159], v[240:243]
    s_waitcnt lgkmcnt(7)
    v_fma_f32 v82, -v68, v82, v82
    v_mfma_f32_16x16x32_bf16 v[240:243], a[32:35], v[58:61], v[240:243]
    s_waitcnt lgkmcnt(6)
    ds_read_b128 v[58:61], v42 offset:11008
    v_mfma_f32_16x16x32_bf16 v[240:243], a[36:39], v[62:65], v[240:243]
    s_waitcnt lgkmcnt(6)
    ds_read_b128 v[62:65], v42 offset:11264
    v_mfma_f32_16x16x32_bf16 v[240:243], a[40:43], v[108:111], v[240:243]
    ds_read_b128 v[108:111], v42 offset:10992
    v_mfma_f32_16x16x32_bf16 v[240:243], a[120:123], v[220:223], v[240:243]
    s_waitcnt lgkmcnt(7)
    v_mfma_f32_16x16x32_bf16 v[240:243], a[44:47], v[112:115], v[240:243]
    s_waitcnt lgkmcnt(6)
    ds_read_b128 v[112:115], v42 offset:11248
    v_mfma_f32_16x16x32_bf16 v[240:243], a[48:51], v[224:227], v[240:243]
    s_waitcnt lgkmcnt(6)
    ds_read_b128 v[224:227], v42 offset:10976
    v_mfma_f32_16x16x32_bf16 v[240:243], a[52:55], v[228:231], v[240:243]
    ds_read_b128 v[228:231], v42 offset:11232
    v_mfma_f32_16x16x32_bf16 v[240:243], a[188:191], v[160:163], v[240:243]
    s_waitcnt lgkmcnt(7)
    v_mfma_f32_16x16x32_bf16 v[240:243], a[56:59], v[232:235], v[240:243]
    s_waitcnt lgkmcnt(6)
    ds_read_b128 v[232:235], v42 offset:10960
    v_mfma_f32_16x16x32_bf16 v[240:243], a[60:63], v[236:239], v[240:243]
    ds_read_b128 v[236:239], v42 offset:11216
    v_mfma_f32_16x16x32_bf16 v[240:243], a[124:127], v[54:57], v[240:243]
    v_mfma_f32_16x16x32_bf16 v[244:247], a[192:195], v[2:5], 0
    v_mfma_f32_16x16x32_bf16 v[244:247], a[128:131], v[164:167], v[244:247]
    v_mfma_f32_16x16x32_bf16 v[244:247], a[196:199], v[6:9], v[244:247]
    s_nop 4
    ds_write_b32 v38, v240 offset:58496
    v_mfma_f32_16x16x32_bf16 v[244:247], a[132:135], v[168:171], v[244:247]
    ds_write_b32 v38, v241 offset:58784
    v_mfma_f32_16x16x32_bf16 v[244:247], a[200:203], v[10:13], v[244:247]
    ds_write_b32 v38, v242 offset:59072
    v_mfma_f32_16x16x32_bf16 v[244:247], a[136:139], v[172:175], v[244:247]
    ds_write_b32 v38, v243 offset:59360
    v_mfma_f32_16x16x32_bf16 v[244:247], a[204:207], v[70:73], v[244:247]
    v_mfma_f32_16x16x32_bf16 v[244:247], a[140:143], v[176:179], v[244:247]
    s_waitcnt lgkmcnt(11)
    v_mfma_f32_16x16x32_bf16 v[244:247], a[64:67], v[58:61], v[244:247]
    s_waitcnt lgkmcnt(10)
    ds_read_b128 v[58:61], v42 offset:10944
    v_mfma_f32_16x16x32_bf16 v[244:247], a[0:3], v[62:65], v[244:247]
    s_waitcnt lgkmcnt(1)
    ds_read_b128 v[62:65], v42 offset:11200
    v_mfma_f32_16x16x32_bf16 v[244:247], a[208:211], v[116:119], v[244:247]
    s_barrier
    ds_read2st64_b32 v[248:249], v39 offset0:40 offset1:45
    v_mfma_f32_16x16x32_bf16 v[244:247], a[68:71], v[108:111], v[244:247]
    ds_read2st64_b32 v[250:251], v39 offset0:50 offset1:55
    v_add_u32 v36, 63616, v38
    v_mfma_f32_16x16x32_bf16 v[244:247], a[144:147], v[180:183], v[244:247]
    ds_read_b128 v[108:111], v42 offset:10928
    v_mfma_f32_16x16x32_bf16 v[244:247], a[4:7], v[112:115], v[244:247]
    ds_read_b128 v[112:115], v42 offset:11184
    v_mfma_f32_16x16x32_bf16 v[244:247], a[212:215], v[120:123], v[244:247]
    v_mfma_f32_16x16x32_bf16 v[244:247], a[72:75], v[224:227], v[244:247]
    ds_read_b128 v[224:227], v42 offset:10912
    v_mfma_f32_16x16x32_bf16 v[244:247], a[8:11], v[228:231], v[244:247]
    ds_read_b128 v[228:231], v42 offset:11168
    v_mfma_f32_16x16x32_bf16 v[244:247], a[148:151], v[184:187], v[244:247]
    s_waitcnt lgkmcnt(5)
    v_fma_f32 v248, v104, v248, v48
    v_fma_f32 v249, v105, v249, v52
    v_mfma_f32_16x16x32_bf16 v[244:247], a[76:79], v[232:235], v[244:247]
    s_waitcnt lgkmcnt(4)
    ds_read_b128 v[232:235], v42 offset:10896
    v_fma_f32 v250, v106, v250, v78
    v_mfma_f32_16x16x32_bf16 v[244:247], a[216:219], v[124:127], v[244:247]
    v_fma_f32 v251, v107, v251, v82
    v_cvt_pk_bf16_f32 v20, v248, v249
    v_mfma_f32_16x16x32_bf16 v[244:247], a[12:15], v[236:239], v[244:247]
    ds_read_b128 v[236:239], v42 offset:11152
    v_cvt_pk_bf16_f32 v21, v250, v251
    v_mfma_f32_16x16x32_bf16 v[244:247], a[152:155], v[188:191], v[244:247]
    s_waitcnt vmcnt(2)
    buffer_store_dwordx2 v[20:21], v24, s[52:55], s49 offen
    v_lshlrev_b32 v104, 16, v22
    v_mfma_f32_16x16x32_bf16 v[244:247], a[80:83], v[58:61], v[244:247]
    ds_read_b128 v[58:61], v42 offset:10880
    v_and_b32 v105, s34, v22
    v_mfma_f32_16x16x32_bf16 v[244:247], a[16:19], v[62:65], v[244:247]
    ds_read_b128 v[62:65], v42 offset:11136
    v_lshlrev_b32 v106, 16, v23
    v_mfma_f32_16x16x32_bf16 v[244:247], a[220:223], v[128:131], v[244:247]
    s_waitcnt lgkmcnt(7)
    v_and_b32 v107, s34, v23
    v_mul_f32 v104, v69, v104
    v_mfma_f32_16x16x32_bf16 v[244:247], a[84:87], v[108:111], v[244:247]
    ds_read_b128 v[108:111], v42 offset:10864
    v_mul_f32 v105, v69, v105
    v_mfma_f32_16x16x32_bf16 v[244:247], a[156:159], v[192:195], v[244:247]
    s_waitcnt lgkmcnt(7)
    v_mul_f32 v106, v69, v106
    v_mul_f32 v107, v69, v107
    v_mfma_f32_16x16x32_bf16 v[244:247], a[20:23], v[112:115], v[244:247]
    ds_read_b128 v[112:115], v42 offset:11120
    v_fma_f32 v49, -v69, v49, v49
    v_mfma_f32_16x16x32_bf16 v[244:247], a[224:227], v[132:135], v[244:247]
    s_waitcnt lgkmcnt(7)
    v_fma_f32 v53, -v69, v53, v53
    v_fma_f32 v79, -v69, v79, v79
    v_mfma_f32_16x16x32_bf16 v[244:247], a[88:91], v[224:227], v[244:247]
    s_waitcnt lgkmcnt(6)
    ds_read_b128 v[224:227], v42 offset:10848
    v_fma_f32 v83, -v69, v83, v83
    v_mfma_f32_16x16x32_bf16 v[244:247], a[24:27], v[228:231], v[244:247]
    ds_read_b128 v[228:231], v42 offset:11104
    v_mfma_f32_16x16x32_bf16 v[244:247], a[160:163], v[196:199], v[244:247]
    s_waitcnt lgkmcnt(7)
    v_mfma_f32_16x16x32_bf16 v[244:247], a[92:95], v[232:235], v[244:247]
    ds_read_b128 v[232:235], v42 offset:10832
    v_mfma_f32_16x16x32_bf16 v[244:247], a[228:231], v[136:139], v[244:247]
    s_waitcnt lgkmcnt(7)
    v_mfma_f32_16x16x32_bf16 v[244:247], a[28:31], v[236:239], v[244:247]
    ds_read_b128 v[236:239], v42 offset:11088
    v_mfma_f32_16x16x32_bf16 v[244:247], a[164:167], v[200:203], v[244:247]
    s_waitcnt lgkmcnt(7)
    v_mfma_f32_16x16x32_bf16 v[244:247], a[96:99], v[58:61], v[244:247]
    s_waitcnt lgkmcnt(6)
    ds_read_b128 v[58:61], v42 offset:10816
    v_mfma_f32_16x16x32_bf16 v[244:247], a[32:35], v[62:65], v[244:247]
    ds_read_b128 v[62:65], v42 offset:11072
    v_mfma_f32_16x16x32_bf16 v[244:247], a[232:235], v[140:143], v[244:247]
    s_waitcnt lgkmcnt(7)
    v_mfma_f32_16x16x32_bf16 v[244:247], a[100:103], v[108:111], v[244:247]
    ds_read_b128 v[108:111], v42 offset:10800
    v_mfma_f32_16x16x32_bf16 v[244:247], a[168:171], v[204:207], v[244:247]
    s_waitcnt lgkmcnt(7)
    v_mfma_f32_16x16x32_bf16 v[244:247], a[36:39], v[112:115], v[244:247]
    ds_read_b128 v[112:115], v42 offset:11056
    v_mfma_f32_16x16x32_bf16 v[244:247], a[236:239], v[144:147], v[244:247]
    s_waitcnt lgkmcnt(7)
    v_mfma_f32_16x16x32_bf16 v[244:247], a[104:107], v[224:227], v[244:247]
    s_waitcnt lgkmcnt(6)
    ds_read_b128 v[224:227], v42 offset:10784
    v_mfma_f32_16x16x32_bf16 v[244:247], a[40:43], v[228:231], v[244:247]
    ds_read_b128 v[228:231], v42 offset:11040
    v_mfma_f32_16x16x32_bf16 v[244:247], a[172:175], v[208:211], v[244:247]
    s_waitcnt lgkmcnt(7)
    v_mfma_f32_16x16x32_bf16 v[244:247], a[108:111], v[232:235], v[244:247]
    ds_read_b128 v[232:235], v42 offset:10768
    v_mfma_f32_16x16x32_bf16 v[244:247], a[240:243], v[148:151], v[244:247]
    s_waitcnt lgkmcnt(7)
    v_mfma_f32_16x16x32_bf16 v[244:247], a[44:47], v[236:239], v[244:247]
    ds_read_b128 v[236:239], v42 offset:11024
    v_mfma_f32_16x16x32_bf16 v[244:247], a[176:179], v[212:215], v[244:247]
    s_waitcnt lgkmcnt(7)
    v_mfma_f32_16x16x32_bf16 v[244:247], a[112:115], v[58:61], v[244:247]
    s_waitcnt lgkmcnt(6)
    v_mfma_f32_16x16x32_bf16 v[244:247], a[48:51], v[62:65], v[244:247]
    v_mfma_f32_16x16x32_bf16 v[244:247], a[244:247], v[152:155], v[244:247]
    s_waitcnt lgkmcnt(5)
    v_mfma_f32_16x16x32_bf16 v[244:247], a[116:119], v[108:111], v[244:247]
    v_mfma_f32_16x16x32_bf16 v[244:247], a[180:183], v[216:219], v[244:247]
    s_waitcnt lgkmcnt(4)
    v_mfma_f32_16x16x32_bf16 v[244:247], a[52:55], v[112:115], v[244:247]
    v_mfma_f32_16x16x32_bf16 v[244:247], a[248:251], v[156:159], v[244:247]
    s_waitcnt lgkmcnt(3)
    v_mfma_f32_16x16x32_bf16 v[244:247], a[120:123], v[224:227], v[244:247]
    s_waitcnt lgkmcnt(2)
    v_mfma_f32_16x16x32_bf16 v[244:247], a[56:59], v[228:231], v[244:247]
    v_mfma_f32_16x16x32_bf16 v[244:247], a[184:187], v[220:223], v[244:247]
    s_waitcnt lgkmcnt(1)
    v_mfma_f32_16x16x32_bf16 v[244:247], a[124:127], v[232:235], v[244:247]
    v_mfma_f32_16x16x32_bf16 v[244:247], a[252:255], v[160:163], v[244:247]
    s_waitcnt lgkmcnt(0)
    v_mfma_f32_16x16x32_bf16 v[244:247], a[60:63], v[236:239], v[244:247]
    v_mfma_f32_16x16x32_bf16 v[244:247], a[188:191], v[54:57], v[244:247]
    s_nop 7
    ds_write2_b32 v36, v244, v245 offset0:0 offset1:72
    ds_write2_b32 v36, v246, v247 offset0:144 offset1:216
    s_waitcnt lgkmcnt(0)
    s_barrier
    ds_read2st64_b32 v[248:249], v39 offset0:60 offset1:65
    ds_read2st64_b32 v[250:251], v39 offset0:70 offset1:75
    s_waitcnt lgkmcnt(1)
    v_fma_f32 v248, v104, v248, v49
    v_fma_f32 v249, v105, v249, v53
    s_waitcnt lgkmcnt(0)
    v_fma_f32 v250, v106, v250, v79
    v_fma_f32 v251, v107, v251, v83
    v_cvt_pk_bf16_f32 v22, v248, v249
    v_cvt_pk_bf16_f32 v23, v250, v251
    buffer_store_dwordx2 v[22:23], v24, s[52:55], s50 offen
L_gated__end_1:
    s_endpgm
.section .rodata,"a"
.p2align 6
.amdhsa_kernel gated_mix__ssm_conv_h3__spectral_fnet__prompt_kernel
  .amdhsa_next_free_vgpr 512
  .amdhsa_next_free_sgpr 102
  .amdhsa_accum_offset 256
  .amdhsa_group_segment_fixed_size 0
  .amdhsa_kernarg_size 120
  .amdhsa_user_sgpr_count 2
  .amdhsa_user_sgpr_kernarg_segment_ptr 1
  .amdhsa_system_sgpr_workgroup_id_x 1
  .amdhsa_float_denorm_mode_32 3
.end_amdhsa_kernel
```
